```python
import torch

def _softmax(x, axis=-1):
    return torch.softmax(x, dim=axis)
def _gelu(x):
    return torch.nn.functional.gelu(x, approximate="tanh")
def _silu(x):
    return torch.nn.functional.silu(x)
def _sigmoid(x):
    return torch.sigmoid(x)
def _layernorm(x, axis=-1, eps=1e-5):
    m = x.mean(dim=axis, keepdim=True)
    v = x.var(dim=axis, keepdim=True, unbiased=False)
    return (x - m) / torch.sqrt(v + eps)
def _scatter_add(tgt, idx, src, axis=0):
    return tgt.clone().index_add_(axis, idx, src)
def _segment_sum(src, seg, n):
    out = torch.zeros((n,) + src.shape[1:], dtype=src.dtype)
    return out.index_add_(0, seg, src)
def _pad(x, pw):
    flat = tuple(v for pair in reversed(pw) for v in pair)
    return torch.nn.functional.pad(x, flat)

kernel_name = 'standalone__gqa_softmax__near_ridge'

def setup_inputs():

    _w = (lambda a: (lambda t: t.to(torch.bfloat16) if t.is_floating_point() else t)(torch.as_tensor(a)))
    B, Hq, Hkv, Sq, Sk, D = 8, 16, 8, 128, 1024, 256
    return {
        "q": _w((lambda *s: torch.randn(*s, dtype=torch.bfloat16) * 0.8)(B, Hq, Sq, D)),
        "k": _w((lambda *s: torch.randn(*s, dtype=torch.bfloat16) * 0.8)(B, Hkv, Sk, D)),
        "v": _w((lambda *s: torch.randn(*s, dtype=torch.bfloat16) * 0.05)(B, Hkv, Sk, D)),
    }

def reference(q, k, v):
    B, Hq, Sq, D = q.shape
    Hkv = k.shape[1]
    rep = Hq // Hkv
    k = (lambda x, n, axis: torch.repeat_interleave(x, n, dim=axis))(k, rep, axis=1)
    v = (lambda x, n, axis: torch.repeat_interleave(x, n, dim=axis))(v, rep, axis=1)
    scale = D ** -0.5
    scores = torch.einsum("bhqd,bhkd->bhqk", q, k) * scale
    p = _softmax(scores, axis=-1)
    return torch.einsum("bhqk,bhkd->bhqd", p, v)
```

```asm
; @launch grid=(256,1,1) block=(256,1,1) lds=152064
.amdgcn_target "amdgcn-amd-amdhsa--gfx950"
.text
.globl standalone__gqa_softmax__near_ridge_kernel
.p2align 8
.type standalone__gqa_softmax__near_ridge_kernel,@function
standalone__gqa_softmax__near_ridge_kernel:
  s_cmp_ge_u32 s2, 256
  s_cbranch_scc1 L_end
  s_load_dwordx8 s[4:11], s[0:1], 0
  s_load_dwordx2 s[14:15], s[0:1], 40
  v_lshrrev_b32 v1, 6, v0
  v_and_b32 v0, 63, v0
  v_readfirstlane_b32 s40, v1
  s_getpc_b64 s[36:37]
  s_lshr_b32 s3, s2, 3
  s_lshl_b32 s3, s3, 2
  v_add_u32 v4, s3, v1
  v_lshlrev_b32 v4, 1, v4
  v_add_u32 v4, v4, v0
  v_lshlrev_b32 v4, 7, v4
  v_min_u32 v4, L_end-standalone__gqa_softmax__near_ridge_kernel-256, v4
  v_mov_b32 v5, s37
  v_add_co_u32 v4, vcc, s36, v4
  s_nop 1
  v_addc_co_u32 v5, vcc, 0, v5, vcc
  s_mov_b64 exec, 3
  global_load_dword a192, v[4:5], off
  s_mov_b64 exec, -1
  v_lshlrev_b32 v18, 4, v0
  s_mov_b32 s54, s2
  s_and_b32 s51, s54, 7
  s_lshr_b32 s52, s54, 3
  s_lshl_b32 s51, s51, 3
  s_lshr_b32 s3, s52, 2
  s_add_u32 s51, s51, s3
  s_bfe_u32 s50, s52, 0x10001
  s_and_b32 s52, s52, 1
  s_lshl_b32 s3, s51, 1
  s_add_u32 s52, s52, s3
  s_lshl_b32 s52, s52, 16
  s_lshl_b32 s51, s51, 19
  s_lshl_b32 s3, s50, 18
  s_add_u32 s51, s51, s3
  s_mov_b32 s54, 50688
  s_cmp_eq_u32 s40, 1
  s_cselect_b32 s54, 101376, s54
  s_cmp_eq_u32 s40, 2
  s_cselect_b32 s54, 118272, s54
  s_cmp_eq_u32 s40, 3
  s_cselect_b32 s54, 135168, s54
  s_lshl_b32 s53, s40, 14
  s_lshl_b32 s41, s40, 12
  s_mov_b32 s42, s41
  s_mul_i32 s43, s40, 4224
  s_add_u32 s44, s43, 67584
  s_mov_b32 s18, 65536
  s_mov_b32 s19, 0x20000
  s_mov_b32 s22, 262144
  s_mov_b32 s23, 0x20000
  s_mov_b32 m0, s43
  s_mov_b32 s55, 33792
  s_mov_b32 s56, 33792
  s_mov_b32 s47, 33792
  s_mov_b32 s48, 33792
  s_lshl_b32 s58, s2, 2
  s_add_u32 s58, s58, s40
  s_lshl_b32 s58, s58, 11
  s_add_u32 s58, s58, 1048576
  s_mov_b32 s34, 3145728
  s_mov_b32 s35, 0x20000
  v_lshlrev_b32 v3, 7, v0
  s_getreg_b32 s49, hwreg(HW_REG_XCC_ID)
  s_and_b32 s49, s49, 15
  v_lshrrev_b32 v6, 3, v0
  v_and_b32 v7, 6, v6
  v_xor_b32 v7, v7, v0
  v_and_b32 v7, 7, v7
  v_lshlrev_b32 v7, 4, v7
  v_lshl_add_u32 v6, v6, 9, v7
  v_xor_b32 v7, 0x200, v6
  s_waitcnt lgkmcnt(0)
  s_add_u32 s20, s6, s51
  s_addc_u32 s21, s7, 0
  buffer_load_dwordx4 v18, s[20:23], s41 offen offset:0 nt lds
  s_add_u32 m0, s43, 32
  s_add_u32 s16, s4, s52
  s_addc_u32 s17, s5, 0
  buffer_load_dwordx4 v18, s[20:23], s41 offen offset:1024 nt lds
  s_add_u32 m0, s43, 64
  s_mov_b32 s32, s14
  s_mov_b32 s33, s15
  buffer_load_dwordx4 v18, s[20:23], s41 offen offset:2048 nt lds
  s_add_u32 m0, s43, 96
  s_add_u32 s24, s8, s51
  s_addc_u32 s25, s9, 0
  buffer_load_dwordx4 v18, s[20:23], s41 offen offset:3072 nt lds
  s_add_u32 s41, s41, 16384
  s_mov_b32 s26, 262144
  s_mov_b32 s27, 0x20000
  s_add_u32 s28, s10, s52
  s_addc_u32 s29, s11, 0
  s_mov_b32 s30, 65536
  s_mov_b32 s31, 0x20000
  s_xor_b32 s57, s58, 131072
  s_mov_b64 exec, 3
  buffer_load_dword v8, v3, s[32:35], s58 offen sc1
  s_mov_b64 exec, -1
  s_add_u32 m0, s54, 0
  s_add_u32 s3, s53, 0
  buffer_load_dwordx4 v6, s[16:19], s3 offen lds
  s_add_u32 m0, s54, 1024
  s_add_u32 s3, s53, 4096
  buffer_load_dwordx4 v7, s[16:19], s3 offen lds
  s_add_u32 m0, s54, 2048
  s_add_u32 s3, s53, 8192
  buffer_load_dwordx4 v6, s[16:19], s3 offen lds
  s_add_u32 m0, s54, 3072
  s_add_u32 s3, s53, 12288
  buffer_load_dwordx4 v7, s[16:19], s3 offen lds
  s_add_u32 m0, s54, 4096
  s_add_u32 s3, s53, 128
  buffer_load_dwordx4 v6, s[16:19], s3 offen lds
  s_add_u32 m0, s54, 5120
  s_add_u32 s3, s53, 4224
  buffer_load_dwordx4 v7, s[16:19], s3 offen lds
  s_add_u32 m0, s54, 6144
  s_add_u32 s3, s53, 8320
  buffer_load_dwordx4 v6, s[16:19], s3 offen lds
  s_add_u32 m0, s54, 7168
  s_add_u32 s3, s53, 12416
  buffer_load_dwordx4 v7, s[16:19], s3 offen lds
  s_lshl_b32 s3, s50, 8
  v_xor_b32 v19, s3, v18
  v_and_b32 v1, 15, v0
  v_lshrrev_b32 v4, 4, v0
  v_mul_u32_u24 v2, 1056, v1
  v_lshl_add_u32 v16, v4, 4, v2
  v_lshrrev_b32 v2, 2, v0
  v_mul_u32_u24 v2, 1056, v2
  v_and_b32 v3, 3, v0
  v_lshl_add_u32 v2, v3, 3, v2
  v_add_u32 v17, 67584, v2
  v_lshlrev_b32 v3, 1, v3
  v_lshrrev_b32 v2, 2, v1
  v_and_b32 v5, 1, v2
  v_xor_b32 v5, v5, v3
  v_lshlrev_b32 v5, 7, v5
  v_lshl_add_u32 v5, v2, 10, v5
  v_xor_b32 v3, v3, v4
  v_lshl_add_u32 v5, v3, 4, v5
  v_add_u32 v28, s54, v5
  v_xor_b32 v3, 128, v5
  v_add_u32 v29, s54, v3
  v_xor_b32 v3, 64, v5
  v_add_u32 v30, s54, v3
  v_xor_b32 v3, 0xc0, v5
  v_add_u32 v31, s54, v3
  v_and_b32 v1, 15, v0
  v_lshrrev_b32 v4, 4, v0
  s_mul_i32 s3, s40, 8704
  v_mul_u32_u24 v5, 272, v1
  v_lshlrev_b32 v21, 3, v4
  v_add3_u32 v13, v5, v21, s3
  v_lshlrev_b32 v21, 4, v1
  v_mul_u32_u24 v5, 272, v4
  v_add3_u32 v14, v5, v21, s3
  v_lshl_add_u32 v12, v4, 10, v21
  v_mov_b32 v15, v21
  v_lshrrev_b32 v5, 3, v0
  v_and_b32 v21, 7, v0
  v_lshlrev_b32 v21, 4, v21
  v_mul_u32_u24 v14, 272, v5
  v_add3_u32 v14, v14, v21, s3
  v_lshl_add_u32 v21, v5, 10, v21
  s_mov_b32 s46, 0x3db8aa3b
  v_mov_b32 v22, 0
  v_mov_b32 v23, 0
  v_mov_b32 v2, s46
  s_add_u32 m0, s54, 8192
  s_add_u32 s3, s53, 256
  buffer_load_dwordx4 v6, s[16:19], s3 offen lds
  s_add_u32 m0, s54, 9216
  s_add_u32 s3, s53, 4352
  buffer_load_dwordx4 v7, s[16:19], s3 offen lds
  s_add_u32 m0, s54, 10240
  s_add_u32 s3, s53, 8448
  buffer_load_dwordx4 v6, s[16:19], s3 offen lds
  s_add_u32 m0, s54, 11264
  s_add_u32 s3, s53, 12544
  buffer_load_dwordx4 v7, s[16:19], s3 offen lds
  s_waitcnt vmcnt(12)
  s_barrier
  ds_read_b128 a[64:67], v16 offset:0
  ds_read_b128 a[68:71], v16 offset:512
  ds_read_b128 a[72:75], v16 offset:64
  ds_read_b128 a[76:79], v16 offset:576
  v_readlane_b32 s51, v8, 0
  v_readlane_b32 s52, v8, 1
  v_mov_b32 v9, 0
  s_nop 0
  s_and_b32 s52, s52, 0xffffff00
  s_add_u32 s52, s52, 0x100
  s_or_b32 s52, s52, s49
  s_xor_b32 s3, s52, s51
  s_cmp_lt_u32 s3, 0x100
  s_cselect_b32 s3, 0x100, 0
  s_add_u32 s59, s52, s3
  v_mov_b32 v8, s59
  buffer_store_dword v8, v9, s[32:35], s58 offen offset:128 sc1
  v_mov_b32 v3, 0
  s_waitcnt vmcnt(9)
  ds_read_b128 v[96:99], v28 offset:0
  ds_read_b128 v[100:103], v29 offset:0
  ds_read_b128 v[104:107], v30 offset:0
  ds_read_b128 v[108:111], v31 offset:0
  s_add_u32 m0, s54, 12288
  s_add_u32 s3, s53, 384
  ds_read_b128 a[80:83], v16 offset:128
  s_waitcnt lgkmcnt(4)
  v_lshlrev_b32 v32, 16, v96
  v_and_b32 v33, 0xffff0000, v96
  v_pk_mul_f32 v[32:33], v[32:33], v[2:3] op_sel_hi:[1,0]
  v_cvt_pk_bf16_f32 v32, v32, v33
  v_accvgpr_write_b32 a0, v32
  v_lshlrev_b32 v34, 16, v97
  v_and_b32 v35, 0xffff0000, v97
  v_pk_mul_f32 v[34:35], v[34:35], v[2:3] op_sel_hi:[1,0]
  v_cvt_pk_bf16_f32 v34, v34, v35
  v_accvgpr_write_b32 a1, v34
  v_lshlrev_b32 v36, 16, v98
  v_and_b32 v37, 0xffff0000, v98
  v_pk_mul_f32 v[36:37], v[36:37], v[2:3] op_sel_hi:[1,0]
  v_cvt_pk_bf16_f32 v36, v36, v37
  v_accvgpr_write_b32 a2, v36
  v_lshlrev_b32 v38, 16, v99
  v_and_b32 v39, 0xffff0000, v99
  v_pk_mul_f32 v[38:39], v[38:39], v[2:3] op_sel_hi:[1,0]
  v_cvt_pk_bf16_f32 v38, v38, v39
  v_accvgpr_write_b32 a3, v38
  buffer_load_dwordx4 v6, s[16:19], s3 offen lds
  s_add_u32 m0, s54, 13312
  s_add_u32 s3, s53, 4480
  ds_read_b128 a[84:87], v16 offset:640
  s_waitcnt lgkmcnt(4)
  v_lshlrev_b32 v40, 16, v100
  v_and_b32 v41, 0xffff0000, v100
  v_pk_mul_f32 v[40:41], v[40:41], v[2:3] op_sel_hi:[1,0]
  v_cvt_pk_bf16_f32 v40, v40, v41
  v_accvgpr_write_b32 a4, v40
  v_lshlrev_b32 v42, 16, v101
  v_and_b32 v43, 0xffff0000, v101
  v_pk_mul_f32 v[42:43], v[42:43], v[2:3] op_sel_hi:[1,0]
  v_cvt_pk_bf16_f32 v42, v42, v43
  v_accvgpr_write_b32 a5, v42
  v_lshlrev_b32 v44, 16, v102
  v_and_b32 v45, 0xffff0000, v102
  v_pk_mul_f32 v[44:45], v[44:45], v[2:3] op_sel_hi:[1,0]
  v_cvt_pk_bf16_f32 v44, v44, v45
  v_accvgpr_write_b32 a6, v44
  v_lshlrev_b32 v46, 16, v103
  v_and_b32 v47, 0xffff0000, v103
  v_pk_mul_f32 v[46:47], v[46:47], v[2:3] op_sel_hi:[1,0]
  v_cvt_pk_bf16_f32 v46, v46, v47
  v_accvgpr_write_b32 a7, v46
  buffer_load_dwordx4 v7, s[16:19], s3 offen lds
  s_add_u32 m0, s54, 14336
  s_add_u32 s3, s53, 8576
  ds_read_b128 a[88:91], v16 offset:192
  s_waitcnt lgkmcnt(4)
  v_lshlrev_b32 v32, 16, v104
  v_and_b32 v33, 0xffff0000, v104
  v_pk_mul_f32 v[32:33], v[32:33], v[2:3] op_sel_hi:[1,0]
  v_cvt_pk_bf16_f32 v32, v32, v33
  v_accvgpr_write_b32 a8, v32
  v_lshlrev_b32 v34, 16, v105
  v_and_b32 v35, 0xffff0000, v105
  v_pk_mul_f32 v[34:35], v[34:35], v[2:3] op_sel_hi:[1,0]
  v_cvt_pk_bf16_f32 v34, v34, v35
  v_accvgpr_write_b32 a9, v34
  v_lshlrev_b32 v36, 16, v106
  v_and_b32 v37, 0xffff0000, v106
  v_pk_mul_f32 v[36:37], v[36:37], v[2:3] op_sel_hi:[1,0]
  v_cvt_pk_bf16_f32 v36, v36, v37
  v_accvgpr_write_b32 a10, v36
  v_lshlrev_b32 v38, 16, v107
  v_and_b32 v39, 0xffff0000, v107
  v_pk_mul_f32 v[38:39], v[38:39], v[2:3] op_sel_hi:[1,0]
  v_cvt_pk_bf16_f32 v38, v38, v39
  v_accvgpr_write_b32 a11, v38
  buffer_load_dwordx4 v6, s[16:19], s3 offen lds
  s_add_u32 m0, s54, 15360
  s_add_u32 s3, s53, 12672
  ds_read_b128 a[92:95], v16 offset:704
  s_waitcnt lgkmcnt(4)
  v_lshlrev_b32 v40, 16, v108
  v_and_b32 v41, 0xffff0000, v108
  v_pk_mul_f32 v[40:41], v[40:41], v[2:3] op_sel_hi:[1,0]
  v_cvt_pk_bf16_f32 v40, v40, v41
  v_accvgpr_write_b32 a12, v40
  v_lshlrev_b32 v42, 16, v109
  v_and_b32 v43, 0xffff0000, v109
  v_pk_mul_f32 v[42:43], v[42:43], v[2:3] op_sel_hi:[1,0]
  v_cvt_pk_bf16_f32 v42, v42, v43
  v_accvgpr_write_b32 a13, v42
  v_lshlrev_b32 v44, 16, v110
  v_and_b32 v45, 0xffff0000, v110
  v_pk_mul_f32 v[44:45], v[44:45], v[2:3] op_sel_hi:[1,0]
  v_cvt_pk_bf16_f32 v44, v44, v45
  v_accvgpr_write_b32 a14, v44
  v_lshlrev_b32 v46, 16, v111
  v_and_b32 v47, 0xffff0000, v111
  v_pk_mul_f32 v[46:47], v[46:47], v[2:3] op_sel_hi:[1,0]
  v_cvt_pk_bf16_f32 v46, v46, v47
  v_accvgpr_write_b32 a15, v46
  buffer_load_dwordx4 v7, s[16:19], s3 offen lds
  s_waitcnt vmcnt(9)
  ds_read_b128 v[112:115], v28 offset:4096
  ds_read_b128 v[116:119], v29 offset:4096
  ds_read_b128 v[120:123], v30 offset:4096
  ds_read_b128 v[124:127], v31 offset:4096
  v_mfma_f32_16x16x32_bf16 v[48:51], a[64:67], a[0:3], 0
  s_add_u32 m0, s43, 16896
  ds_read_b128 a[96:99], v16 offset:256
  s_waitcnt lgkmcnt(4)
  v_lshlrev_b32 v32, 16, v112
  v_and_b32 v33, 0xffff0000, v112
  v_pk_mul_f32 v[32:33], v[32:33], v[2:3] op_sel_hi:[1,0]
  v_cvt_pk_bf16_f32 v32, v32, v33
  v_accvgpr_write_b32 a16, v32
  v_lshlrev_b32 v34, 16, v113
  v_and_b32 v35, 0xffff0000, v113
  v_pk_mul_f32 v[34:35], v[34:35], v[2:3] op_sel_hi:[1,0]
  v_cvt_pk_bf16_f32 v34, v34, v35
  v_accvgpr_write_b32 a17, v34
  v_lshlrev_b32 v36, 16, v114
  v_mfma_f32_16x16x32_bf16 v[56:59], a[64:67], a[4:7], 0
  buffer_load_dwordx4 v18, s[20:23], s41 offen offset:0 nt lds
  v_and_b32 v37, 0xffff0000, v114
  v_pk_mul_f32 v[36:37], v[36:37], v[2:3] op_sel_hi:[1,0]
  v_cvt_pk_bf16_f32 v36, v36, v37
  v_accvgpr_write_b32 a18, v36
  v_lshlrev_b32 v38, 16, v115
  v_and_b32 v39, 0xffff0000, v115
  v_pk_mul_f32 v[38:39], v[38:39], v[2:3] op_sel_hi:[1,0]
  v_cvt_pk_bf16_f32 v38, v38, v39
  v_accvgpr_write_b32 a19, v38
  s_waitcnt lgkmcnt(3)
  v_lshlrev_b32 v40, 16, v116
  v_and_b32 v41, 0xffff0000, v116
  v_mfma_f32_16x16x32_bf16 v[52:55], a[68:71], a[0:3], 0
  s_add_u32 m0, s43, 16928
  ds_read_b128 a[100:103], v16 offset:768
  v_pk_mul_f32 v[40:41], v[40:41], v[2:3] op_sel_hi:[1,0]
  v_cvt_pk_bf16_f32 v40, v40, v41
  v_accvgpr_write_b32 a20, v40
  v_lshlrev_b32 v42, 16, v117
  v_and_b32 v43, 0xffff0000, v117
  v_pk_mul_f32 v[42:43], v[42:43], v[2:3] op_sel_hi:[1,0]
  v_cvt_pk_bf16_f32 v42, v42, v43
  v_accvgpr_write_b32 a21, v42
  v_lshlrev_b32 v44, 16, v118
  v_and_b32 v45, 0xffff0000, v118
  v_pk_mul_f32 v[44:45], v[44:45], v[2:3] op_sel_hi:[1,0]
  v_mfma_f32_16x16x32_bf16 v[60:63], a[68:71], a[4:7], 0
  buffer_load_dwordx4 v18, s[20:23], s41 offen offset:1024 nt lds
  v_cvt_pk_bf16_f32 v44, v44, v45
  v_accvgpr_write_b32 a22, v44
  v_lshlrev_b32 v46, 16, v119
  v_and_b32 v47, 0xffff0000, v119
  v_pk_mul_f32 v[46:47], v[46:47], v[2:3] op_sel_hi:[1,0]
  v_cvt_pk_bf16_f32 v46, v46, v47
  v_accvgpr_write_b32 a23, v46
  s_waitcnt lgkmcnt(3)
  v_lshlrev_b32 v32, 16, v120
  v_and_b32 v33, 0xffff0000, v120
  v_pk_mul_f32 v[32:33], v[32:33], v[2:3] op_sel_hi:[1,0]
  v_cvt_pk_bf16_f32 v32, v32, v33
  v_mfma_f32_16x16x32_bf16 v[48:51], a[72:75], a[8:11], v[48:51]
  s_add_u32 m0, s43, 16960
  ds_read_b128 a[104:107], v16 offset:320
  v_accvgpr_write_b32 a24, v32
  v_lshlrev_b32 v34, 16, v121
  v_and_b32 v35, 0xffff0000, v121
  v_pk_mul_f32 v[34:35], v[34:35], v[2:3] op_sel_hi:[1,0]
  v_cvt_pk_bf16_f32 v34, v34, v35
  v_accvgpr_write_b32 a25, v34
  v_lshlrev_b32 v36, 16, v122
  v_and_b32 v37, 0xffff0000, v122
  v_pk_mul_f32 v[36:37], v[36:37], v[2:3] op_sel_hi:[1,0]
  v_cvt_pk_bf16_f32 v36, v36, v37
  v_accvgpr_write_b32 a26, v36
  v_mfma_f32_16x16x32_bf16 v[56:59], a[72:75], a[12:15], v[56:59]
  buffer_load_dwordx4 v18, s[20:23], s41 offen offset:2048 nt lds
  v_lshlrev_b32 v38, 16, v123
  v_and_b32 v39, 0xffff0000, v123
  v_pk_mul_f32 v[38:39], v[38:39], v[2:3] op_sel_hi:[1,0]
  v_cvt_pk_bf16_f32 v38, v38, v39
  v_accvgpr_write_b32 a27, v38
  s_waitcnt lgkmcnt(3)
  v_lshlrev_b32 v40, 16, v124
  v_and_b32 v41, 0xffff0000, v124
  v_pk_mul_f32 v[40:41], v[40:41], v[2:3] op_sel_hi:[1,0]
  v_cvt_pk_bf16_f32 v40, v40, v41
  v_accvgpr_write_b32 a28, v40
  v_lshlrev_b32 v42, 16, v125
  v_mfma_f32_16x16x32_bf16 v[52:55], a[76:79], a[8:11], v[52:55]
  s_add_u32 m0, s43, 16992
  ds_read_b128 a[108:111], v16 offset:832
  v_and_b32 v43, 0xffff0000, v125
  v_pk_mul_f32 v[42:43], v[42:43], v[2:3] op_sel_hi:[1,0]
  v_cvt_pk_bf16_f32 v42, v42, v43
  v_accvgpr_write_b32 a29, v42
  v_lshlrev_b32 v44, 16, v126
  v_and_b32 v45, 0xffff0000, v126
  v_pk_mul_f32 v[44:45], v[44:45], v[2:3] op_sel_hi:[1,0]
  v_cvt_pk_bf16_f32 v44, v44, v45
  v_accvgpr_write_b32 a30, v44
  v_lshlrev_b32 v46, 16, v127
  v_and_b32 v47, 0xffff0000, v127
  v_mfma_f32_16x16x32_bf16 v[60:63], a[76:79], a[12:15], v[60:63]
  buffer_load_dwordx4 v18, s[20:23], s41 offen offset:3072 nt lds
  v_pk_mul_f32 v[46:47], v[46:47], v[2:3] op_sel_hi:[1,0]
  v_cvt_pk_bf16_f32 v46, v46, v47
  v_accvgpr_write_b32 a31, v46
  s_add_u32 s41, s41, 16384
  s_add_u32 s43, s43, s55
  s_sub_u32 s55, 0, s55
  s_waitcnt vmcnt(9)
  ds_read_b128 v[96:99], v28 offset:8192
  ds_read_b128 v[100:103], v29 offset:8192
  ds_read_b128 v[104:107], v30 offset:8192
  ds_read_b128 v[108:111], v31 offset:8192
  v_mfma_f32_16x16x32_bf16 v[48:51], a[80:83], a[16:19], v[48:51]
  s_add_u32 m0, s43, 0
  ds_read_b128 a[112:115], v16 offset:384
  s_waitcnt lgkmcnt(4)
  v_lshlrev_b32 v32, 16, v96
  v_and_b32 v33, 0xffff0000, v96
  v_pk_mul_f32 v[32:33], v[32:33], v[2:3] op_sel_hi:[1,0]
  v_cvt_pk_bf16_f32 v32, v32, v33
  v_accvgpr_write_b32 a32, v32
  v_lshlrev_b32 v34, 16, v97
  v_and_b32 v35, 0xffff0000, v97
  v_pk_mul_f32 v[34:35], v[34:35], v[2:3] op_sel_hi:[1,0]
  v_cvt_pk_bf16_f32 v34, v34, v35
  v_accvgpr_write_b32 a33, v34
  v_lshlrev_b32 v36, 16, v98
  v_mfma_f32_16x16x32_bf16 v[56:59], a[80:83], a[20:23], v[56:59]
  buffer_load_dwordx4 v18, s[20:23], s41 offen offset:0 nt lds
  v_and_b32 v37, 0xffff0000, v98
  v_pk_mul_f32 v[36:37], v[36:37], v[2:3] op_sel_hi:[1,0]
  v_cvt_pk_bf16_f32 v36, v36, v37
  v_accvgpr_write_b32 a34, v36
  v_lshlrev_b32 v38, 16, v99
  v_and_b32 v39, 0xffff0000, v99
  v_pk_mul_f32 v[38:39], v[38:39], v[2:3] op_sel_hi:[1,0]
  v_cvt_pk_bf16_f32 v38, v38, v39
  v_accvgpr_write_b32 a35, v38
  s_waitcnt lgkmcnt(3)
  v_lshlrev_b32 v40, 16, v100
  v_and_b32 v41, 0xffff0000, v100
  v_mfma_f32_16x16x32_bf16 v[52:55], a[84:87], a[16:19], v[52:55]
  s_add_u32 m0, s43, 32
  ds_read_b128 a[116:119], v16 offset:896
  v_pk_mul_f32 v[40:41], v[40:41], v[2:3] op_sel_hi:[1,0]
  v_cvt_pk_bf16_f32 v40, v40, v41
  v_accvgpr_write_b32 a36, v40
  v_lshlrev_b32 v42, 16, v101
  v_and_b32 v43, 0xffff0000, v101
  v_pk_mul_f32 v[42:43], v[42:43], v[2:3] op_sel_hi:[1,0]
  v_cvt_pk_bf16_f32 v42, v42, v43
  v_accvgpr_write_b32 a37, v42
  v_lshlrev_b32 v44, 16, v102
  v_and_b32 v45, 0xffff0000, v102
  v_pk_mul_f32 v[44:45], v[44:45], v[2:3] op_sel_hi:[1,0]
  v_mfma_f32_16x16x32_bf16 v[60:63], a[84:87], a[20:23], v[60:63]
  buffer_load_dwordx4 v18, s[20:23], s41 offen offset:1024 nt lds
  v_cvt_pk_bf16_f32 v44, v44, v45
  v_accvgpr_write_b32 a38, v44
  v_lshlrev_b32 v46, 16, v103
  v_and_b32 v47, 0xffff0000, v103
  v_pk_mul_f32 v[46:47], v[46:47], v[2:3] op_sel_hi:[1,0]
  v_cvt_pk_bf16_f32 v46, v46, v47
  v_accvgpr_write_b32 a39, v46
  s_waitcnt lgkmcnt(3)
  v_lshlrev_b32 v32, 16, v104
  v_and_b32 v33, 0xffff0000, v104
  v_pk_mul_f32 v[32:33], v[32:33], v[2:3] op_sel_hi:[1,0]
  v_cvt_pk_bf16_f32 v32, v32, v33
  v_mfma_f32_16x16x32_bf16 v[48:51], a[88:91], a[24:27], v[48:51]
  s_add_u32 m0, s43, 64
  ds_read_b128 a[120:123], v16 offset:448
  v_accvgpr_write_b32 a40, v32
  v_lshlrev_b32 v34, 16, v105
  v_and_b32 v35, 0xffff0000, v105
  v_pk_mul_f32 v[34:35], v[34:35], v[2:3] op_sel_hi:[1,0]
  v_cvt_pk_bf16_f32 v34, v34, v35
  v_accvgpr_write_b32 a41, v34
  v_lshlrev_b32 v36, 16, v106
  v_and_b32 v37, 0xffff0000, v106
  v_pk_mul_f32 v[36:37], v[36:37], v[2:3] op_sel_hi:[1,0]
  v_cvt_pk_bf16_f32 v36, v36, v37
  v_accvgpr_write_b32 a42, v36
  v_mfma_f32_16x16x32_bf16 v[56:59], a[88:91], a[28:31], v[56:59]
  buffer_load_dwordx4 v18, s[20:23], s41 offen offset:2048 nt lds
  v_lshlrev_b32 v38, 16, v107
  v_and_b32 v39, 0xffff0000, v107
  v_pk_mul_f32 v[38:39], v[38:39], v[2:3] op_sel_hi:[1,0]
  v_cvt_pk_bf16_f32 v38, v38, v39
  v_accvgpr_write_b32 a43, v38
  s_waitcnt lgkmcnt(3)
  v_lshlrev_b32 v40, 16, v108
  v_and_b32 v41, 0xffff0000, v108
  v_pk_mul_f32 v[40:41], v[40:41], v[2:3] op_sel_hi:[1,0]
  v_cvt_pk_bf16_f32 v40, v40, v41
  v_accvgpr_write_b32 a44, v40
  v_lshlrev_b32 v42, 16, v109
  v_mfma_f32_16x16x32_bf16 v[52:55], a[92:95], a[24:27], v[52:55]
  s_add_u32 m0, s43, 96
  ds_read_b128 a[124:127], v16 offset:960
  v_and_b32 v43, 0xffff0000, v109
  v_pk_mul_f32 v[42:43], v[42:43], v[2:3] op_sel_hi:[1,0]
  v_cvt_pk_bf16_f32 v42, v42, v43
  v_accvgpr_write_b32 a45, v42
  v_lshlrev_b32 v44, 16, v110
  v_and_b32 v45, 0xffff0000, v110
  v_pk_mul_f32 v[44:45], v[44:45], v[2:3] op_sel_hi:[1,0]
  v_cvt_pk_bf16_f32 v44, v44, v45
  v_accvgpr_write_b32 a46, v44
  v_lshlrev_b32 v46, 16, v111
  v_and_b32 v47, 0xffff0000, v111
  v_mfma_f32_16x16x32_bf16 v[60:63], a[92:95], a[28:31], v[60:63]
  buffer_load_dwordx4 v18, s[20:23], s41 offen offset:3072 nt lds
  v_pk_mul_f32 v[46:47], v[46:47], v[2:3] op_sel_hi:[1,0]
  v_cvt_pk_bf16_f32 v46, v46, v47
  v_accvgpr_write_b32 a47, v46
  s_add_u32 s41, s41, 16384
  s_waitcnt vmcnt(8)
  ds_read_b128 v[112:115], v28 offset:12288
  ds_read_b128 v[116:119], v29 offset:12288
  ds_read_b128 v[120:123], v30 offset:12288
  ds_read_b128 v[124:127], v31 offset:12288
  v_mfma_f32_16x16x32_bf16 v[48:51], a[96:99], a[32:35], v[48:51]
  s_add_u32 m0, s44, 0
  s_waitcnt lgkmcnt(3)
  v_lshlrev_b32 v32, 16, v112
  v_and_b32 v33, 0xffff0000, v112
  v_pk_mul_f32 v[32:33], v[32:33], v[2:3] op_sel_hi:[1,0]
  v_cvt_pk_bf16_f32 v32, v32, v33
  v_accvgpr_write_b32 a48, v32
  v_lshlrev_b32 v34, 16, v113
  v_and_b32 v35, 0xffff0000, v113
  v_pk_mul_f32 v[34:35], v[34:35], v[2:3] op_sel_hi:[1,0]
  v_cvt_pk_bf16_f32 v34, v34, v35
  v_accvgpr_write_b32 a49, v34
  v_lshlrev_b32 v36, 16, v114
  v_and_b32 v37, 0xffff0000, v114
  v_mfma_f32_16x16x32_bf16 v[56:59], a[96:99], a[36:39], v[56:59]
  buffer_load_dwordx4 v19, s[24:27], s42 offen offset:0 nt lds
  v_pk_mul_f32 v[36:37], v[36:37], v[2:3] op_sel_hi:[1,0]
  v_cvt_pk_bf16_f32 v36, v36, v37
  v_accvgpr_write_b32 a50, v36
  v_lshlrev_b32 v38, 16, v115
  v_and_b32 v39, 0xffff0000, v115
  v_pk_mul_f32 v[38:39], v[38:39], v[2:3] op_sel_hi:[1,0]
  v_cvt_pk_bf16_f32 v38, v38, v39
  v_accvgpr_write_b32 a51, v38
  s_waitcnt lgkmcnt(2)
  v_lshlrev_b32 v40, 16, v116
  v_and_b32 v41, 0xffff0000, v116
  v_pk_mul_f32 v[40:41], v[40:41], v[2:3] op_sel_hi:[1,0]
  v_mfma_f32_16x16x32_bf16 v[52:55], a[100:103], a[32:35], v[52:55]
  s_add_u32 m0, s44, 32
  v_cvt_pk_bf16_f32 v40, v40, v41
  v_accvgpr_write_b32 a52, v40
  v_lshlrev_b32 v42, 16, v117
  v_and_b32 v43, 0xffff0000, v117
  v_pk_mul_f32 v[42:43], v[42:43], v[2:3] op_sel_hi:[1,0]
  v_cvt_pk_bf16_f32 v42, v42, v43
  v_accvgpr_write_b32 a53, v42
  v_lshlrev_b32 v44, 16, v118
  v_and_b32 v45, 0xffff0000, v118
  v_pk_mul_f32 v[44:45], v[44:45], v[2:3] op_sel_hi:[1,0]
  v_cvt_pk_bf16_f32 v44, v44, v45
  v_mfma_f32_16x16x32_bf16 v[60:63], a[100:103], a[36:39], v[60:63]
  buffer_load_dwordx4 v19, s[24:27], s42 offen offset:1024 nt lds
  v_accvgpr_write_b32 a54, v44
  v_lshlrev_b32 v46, 16, v119
  v_and_b32 v47, 0xffff0000, v119
  v_pk_mul_f32 v[46:47], v[46:47], v[2:3] op_sel_hi:[1,0]
  v_cvt_pk_bf16_f32 v46, v46, v47
  v_accvgpr_write_b32 a55, v46
  s_waitcnt lgkmcnt(1)
  v_lshlrev_b32 v32, 16, v120
  v_and_b32 v33, 0xffff0000, v120
  v_pk_mul_f32 v[32:33], v[32:33], v[2:3] op_sel_hi:[1,0]
  v_cvt_pk_bf16_f32 v32, v32, v33
  v_accvgpr_write_b32 a56, v32
  v_mfma_f32_16x16x32_bf16 v[48:51], a[104:107], a[40:43], v[48:51]
  s_add_u32 m0, s44, 64
  v_lshlrev_b32 v34, 16, v121
  v_and_b32 v35, 0xffff0000, v121
  v_pk_mul_f32 v[34:35], v[34:35], v[2:3] op_sel_hi:[1,0]
  v_cvt_pk_bf16_f32 v34, v34, v35
  v_accvgpr_write_b32 a57, v34
  v_lshlrev_b32 v36, 16, v122
  v_and_b32 v37, 0xffff0000, v122
  v_pk_mul_f32 v[36:37], v[36:37], v[2:3] op_sel_hi:[1,0]
  v_cvt_pk_bf16_f32 v36, v36, v37
  v_accvgpr_write_b32 a58, v36
  v_lshlrev_b32 v38, 16, v123
  v_and_b32 v39, 0xffff0000, v123
  v_mfma_f32_16x16x32_bf16 v[56:59], a[104:107], a[44:47], v[56:59]
  buffer_load_dwordx4 v19, s[24:27], s42 offen offset:2048 nt lds
  v_pk_mul_f32 v[38:39], v[38:39], v[2:3] op_sel_hi:[1,0]
  v_cvt_pk_bf16_f32 v38, v38, v39
  v_accvgpr_write_b32 a59, v38
  s_waitcnt lgkmcnt(0)
  v_lshlrev_b32 v40, 16, v124
  v_and_b32 v41, 0xffff0000, v124
  v_pk_mul_f32 v[40:41], v[40:41], v[2:3] op_sel_hi:[1,0]
  v_cvt_pk_bf16_f32 v40, v40, v41
  v_accvgpr_write_b32 a60, v40
  v_lshlrev_b32 v42, 16, v125
  v_and_b32 v43, 0xffff0000, v125
  v_pk_mul_f32 v[42:43], v[42:43], v[2:3] op_sel_hi:[1,0]
  v_mfma_f32_16x16x32_bf16 v[52:55], a[108:111], a[40:43], v[52:55]
  s_add_u32 m0, s44, 96
  v_cvt_pk_bf16_f32 v42, v42, v43
  v_accvgpr_write_b32 a61, v42
  v_lshlrev_b32 v44, 16, v126
  v_and_b32 v45, 0xffff0000, v126
  v_pk_mul_f32 v[44:45], v[44:45], v[2:3] op_sel_hi:[1,0]
  v_cvt_pk_bf16_f32 v44, v44, v45
  v_accvgpr_write_b32 a62, v44
  v_lshlrev_b32 v46, 16, v127
  v_and_b32 v47, 0xffff0000, v127
  v_pk_mul_f32 v[46:47], v[46:47], v[2:3] op_sel_hi:[1,0]
  v_cvt_pk_bf16_f32 v46, v46, v47
  v_accvgpr_write_b32 a63, v46
  v_mfma_f32_16x16x32_bf16 v[60:63], a[108:111], a[44:47], v[60:63]
  buffer_load_dwordx4 v19, s[24:27], s42 offen offset:3072 nt lds
  s_add_u32 s42, s42, 16384
  s_mov_b32 s60, 0x43800000
  v_mfma_f32_16x16x32_bf16 v[48:51], a[112:115], a[48:51], v[48:51]
  s_mov_b32 s45, 3
  v_mfma_f32_16x16x32_bf16 v[56:59], a[112:115], a[52:55], v[56:59]
  s_lshl_b32 s54, s50, 8
  s_add_u32 s54, s53, s54
  s_xor_b32 s53, s54, 256
  s_mov_b32 s51, s54
  v_mfma_f32_16x16x32_bf16 v[52:55], a[116:119], a[48:51], v[52:55]
  s_waitcnt vmcnt(8) lgkmcnt(0)
  s_barrier
  v_mfma_f32_16x16x32_bf16 v[60:63], a[116:119], a[52:55], v[60:63]
  ds_read_b128 a[128:131], v16 offset:16896
  ds_read_b128 a[132:135], v16 offset:17408
  v_mfma_f32_16x16x32_bf16 v[48:51], a[120:123], a[56:59], v[48:51]
  s_add_u32 m0, s44, 16896
  ds_read_b128 a[136:139], v16 offset:16960
  v_mfma_f32_16x16x32_bf16 v[56:59], a[120:123], a[60:63], v[56:59]
  buffer_load_dwordx4 v19, s[24:27], s42 offen offset:0 nt lds
  ds_read_b128 a[140:143], v16 offset:17472
  v_mfma_f32_16x16x32_bf16 v[52:55], a[124:127], a[56:59], v[52:55]
  ds_read_b128 a[144:147], v16 offset:17024
  v_mfma_f32_16x16x32_bf16 v[60:63], a[124:127], a[60:63], v[60:63]
  s_waitcnt lgkmcnt(3)
  s_add_u32 m0, s44, 16928
  ds_read_b128 a[148:151], v16 offset:17536
  v_mfma_f32_16x16x32_bf16 v[64:67], a[128:131], a[0:3], 0
  buffer_load_dwordx4 v19, s[24:27], s42 offen offset:1024 nt lds
  v_mfma_f32_16x16x32_bf16 v[72:75], a[128:131], a[4:7], 0
  ds_read_b128 a[152:155], v16 offset:17088
  v_mfma_f32_16x16x32_bf16 v[68:71], a[132:135], a[0:3], 0
  s_add_u32 m0, s44, 16960
  v_max3_f32 v1, v48, v49, v50
  v_max3_f32 v1, v1, v51, v52
  v_mfma_f32_16x16x32_bf16 v[76:79], a[132:135], a[4:7], 0
  s_waitcnt lgkmcnt(3)
  buffer_load_dwordx4 v19, s[24:27], s42 offen offset:2048 nt lds
  v_max3_f32 v1, v1, v53, v54
  v_max_f32 v1, v1, v55
  v_mfma_f32_16x16x32_bf16 v[64:67], a[136:139], a[8:11], v[64:67]
  ds_read_b128 a[156:159], v16 offset:17600
  v_max3_f32 v4, v56, v57, v58
  v_mfma_f32_16x16x32_bf16 v[72:75], a[136:139], a[12:15], v[72:75]
  s_add_u32 m0, s44, 16992
  v_max3_f32 v4, v4, v59, v60
  v_max3_f32 v4, v4, v61, v62
  v_mfma_f32_16x16x32_bf16 v[68:71], a[140:143], a[8:11], v[68:71]
  buffer_load_dwordx4 v19, s[24:27], s42 offen offset:3072 nt lds
  ds_read_b128 a[160:163], v16 offset:17152
  v_max_f32 v4, v4, v63
  v_mfma_f32_16x16x32_bf16 v[76:79], a[140:143], a[12:15], v[76:79]
  s_waitcnt lgkmcnt(3)
  s_add_u32 s42, s42, 16384
  s_add_u32 s44, s44, s56
  s_sub_u32 s56, 0, s56
  v_mov_b32 v6, v1
  v_mov_b32 v7, v4
  v_mfma_f32_16x16x32_bf16 v[64:67], a[144:147], a[16:19], v[64:67]
  s_add_u32 m0, s43, 16896
  ds_read_b128 a[164:167], v16 offset:17664
  v_permlane16_swap_b32 v6, v1
  v_mfma_f32_16x16x32_bf16 v[72:75], a[144:147], a[20:23], v[72:75]
  buffer_load_dwordx4 v18, s[20:23], s41 offen offset:0 nt lds
  v_permlane16_swap_b32 v7, v4
  v_max_f32 v1, v1, v6
  v_mfma_f32_16x16x32_bf16 v[68:71], a[148:151], a[16:19], v[68:71]
  ds_read_b128 a[168:171], v16 offset:17216
  v_max_f32 v4, v4, v7
  v_mfma_f32_16x16x32_bf16 v[76:79], a[148:151], a[20:23], v[76:79]
  s_waitcnt lgkmcnt(3)
  s_add_u32 m0, s43, 16928
  v_mov_b32 v6, v1
  v_mov_b32 v7, v4
  v_mfma_f32_16x16x32_bf16 v[64:67], a[152:155], a[24:27], v[64:67]
  buffer_load_dwordx4 v18, s[20:23], s41 offen offset:1024 nt lds
  ds_read_b128 a[172:175], v16 offset:17728
  v_permlane32_swap_b32 v6, v1
  v_permlane32_swap_b32 v7, v4
  v_mfma_f32_16x16x32_bf16 v[72:75], a[152:155], a[28:31], v[72:75]
  v_max_f32 v1, v1, v6
  v_mfma_f32_16x16x32_bf16 v[68:71], a[156:159], a[24:27], v[68:71]
  s_add_u32 m0, s43, 16960
  ds_read_b128 a[176:179], v16 offset:17280
  v_max_f32 v4, v4, v7
  v_sub_f32 v96, v48, v1
  v_mfma_f32_16x16x32_bf16 v[76:79], a[156:159], a[28:31], v[76:79]
  s_waitcnt lgkmcnt(3)
  buffer_load_dwordx4 v18, s[20:23], s41 offen offset:2048 nt lds
  v_sub_f32 v97, v49, v1
  v_mfma_f32_16x16x32_bf16 v[64:67], a[160:163], a[32:35], v[64:67]
  ds_read_b128 a[180:183], v16 offset:17792
  v_sub_f32 v98, v50, v1
  v_sub_f32 v99, v51, v1
  v_mfma_f32_16x16x32_bf16 v[72:75], a[160:163], a[36:39], v[72:75]
  s_add_u32 m0, s43, 16992
  v_sub_f32 v100, v52, v1
  v_mfma_f32_16x16x32_bf16 v[68:71], a[164:167], a[32:35], v[68:71]
  buffer_load_dwordx4 v18, s[20:23], s41 offen offset:3072 nt lds
  ds_read_b128 a[184:187], v16 offset:17344
  v_sub_f32 v101, v53, v1
  v_sub_f32 v102, v54, v1
  v_mfma_f32_16x16x32_bf16 v[76:79], a[164:167], a[36:39], v[76:79]
  s_waitcnt lgkmcnt(3)
  s_add_u32 s41, s41, 16384
  s_add_u32 s43, s43, s55
  s_sub_u32 s55, 0, s55
  v_sub_f32 v103, v55, v1
  v_mfma_f32_16x16x32_bf16 v[64:67], a[168:171], a[40:43], v[64:67]
  s_add_u32 m0, s43, 0
  ds_read_b128 a[188:191], v16 offset:17856
  v_sub_f32 v104, v56, v4
  v_sub_f32 v105, v57, v4
  v_mfma_f32_16x16x32_bf16 v[72:75], a[168:171], a[44:47], v[72:75]
  buffer_load_dwordx4 v18, s[20:23], s41 offen offset:0 nt lds
  v_sub_f32 v106, v58, v4
  v_sub_f32 v107, v59, v4
  v_mfma_f32_16x16x32_bf16 v[68:71], a[172:175], a[40:43], v[68:71]
  v_sub_f32 v108, v60, v4
  v_mfma_f32_16x16x32_bf16 v[76:79], a[172:175], a[44:47], v[76:79]
  s_waitcnt lgkmcnt(2)
  s_add_u32 m0, s43, 32
  v_sub_f32 v109, v61, v4
  v_sub_f32 v110, v62, v4
  v_mfma_f32_16x16x32_bf16 v[64:67], a[176:179], a[48:51], v[64:67]
  buffer_load_dwordx4 v18, s[20:23], s41 offen offset:1024 nt lds
  v_sub_f32 v111, v63, v4
  v_mfma_f32_16x16x32_bf16 v[72:75], a[176:179], a[52:55], v[72:75]
  v_mov_b32 v8, 0
  v_mov_b32 v9, 0
  v_mfma_f32_16x16x32_bf16 v[68:71], a[180:183], a[48:51], v[68:71]
  s_add_u32 m0, s43, 64
  v_sub_f32 v24, 0, v1
  v_mfma_f32_16x16x32_bf16 v[76:79], a[180:183], a[52:55], v[76:79]
  s_waitcnt lgkmcnt(0)
  buffer_load_dwordx4 v18, s[20:23], s41 offen offset:2048 nt lds
  v_sub_f32 v25, 0, v1
  v_sub_f32 v26, 0, v1
  v_mfma_f32_16x16x32_bf16 v[64:67], a[184:187], a[56:59], v[64:67]
  v_sub_f32 v27, 0, v1
  v_mfma_f32_16x16x32_bf16 v[72:75], a[184:187], a[60:63], v[72:75]
  s_add_u32 m0, s43, 96
  v_sub_f32 v28, 0, v4
  v_sub_f32 v29, 0, v4
  v_mfma_f32_16x16x32_bf16 v[68:71], a[188:191], a[56:59], v[68:71]
  buffer_load_dwordx4 v18, s[20:23], s41 offen offset:3072 nt lds
  v_sub_f32 v30, 0, v4
  v_sub_f32 v31, 0, v4
  v_mfma_f32_16x16x32_bf16 v[76:79], a[188:191], a[60:63], v[76:79]
  s_add_u32 s41, s41, 16384
  v_add_u32 v16, s47, v16
  s_sub_u32 s47, 0, s47
  s_waitcnt vmcnt(12)
  s_barrier
  ds_read_b128 a[64:67], v16 offset:0
  ds_read_b128 a[68:71], v16 offset:512
  ds_read_b128 a[72:75], v16 offset:64
  ds_read_b128 a[76:79], v16 offset:576
  ds_read_b128 a[80:83], v16 offset:128
  ds_read_b128 a[84:87], v16 offset:640
  ds_read_b128 a[88:91], v16 offset:192
  ds_read_b128 a[92:95], v16 offset:704
  s_add_u32 m0, s44, 0
  buffer_load_dword v2, v3, s[32:35], s57 offen offset:128 sc1
  buffer_load_dwordx4 v19, s[24:27], s42 offen offset:0 nt lds
  v_sub_f32 v64, v64, v1
  v_sub_f32 v65, v65, v1
  v_sub_f32 v66, v66, v1
  v_sub_f32 v67, v67, v1
  v_sub_f32 v68, v68, v1
  v_sub_f32 v69, v69, v1
  v_sub_f32 v70, v70, v1
  v_sub_f32 v71, v71, v1
  v_sub_f32 v72, v72, v4
  v_sub_f32 v73, v73, v4
  v_sub_f32 v74, v74, v4
  v_sub_f32 v75, v75, v4
  v_sub_f32 v76, v76, v4
  v_sub_f32 v77, v77, v4
  v_sub_f32 v78, v78, v4
  v_sub_f32 v79, v79, v4
  s_waitcnt lgkmcnt(6)
  v_mfma_f32_16x16x32_bf16 v[48:51], a[64:67], a[0:3], v[24:27]
  v_mfma_f32_16x16x32_bf16 v[56:59], a[64:67], a[4:7], v[28:31]
  ds_read_b128 a[96:99], v16 offset:256
  v_mfma_f32_16x16x32_bf16 v[52:55], a[68:71], a[0:3], v[24:27]
  s_add_u32 m0, s44, 32
  ds_read_b128 a[100:103], v16 offset:768
  buffer_load_dwordx4 v19, s[24:27], s42 offen offset:1024 nt lds
  v_mfma_f32_16x16x32_bf16 v[60:63], a[68:71], a[4:7], v[28:31]
  s_waitcnt lgkmcnt(6)
  ds_read_b128 a[104:107], v16 offset:320
  v_mfma_f32_16x16x32_bf16 v[48:51], a[72:75], a[8:11], v[48:51]
  v_mfma_f32_16x16x32_bf16 v[56:59], a[72:75], a[12:15], v[56:59]
  ds_read_b128 a[108:111], v16 offset:832
  v_mfma_f32_16x16x32_bf16 v[52:55], a[76:79], a[8:11], v[52:55]
  ds_read_b128 a[112:115], v16 offset:384
  v_mfma_f32_16x16x32_bf16 v[60:63], a[76:79], a[12:15], v[60:63]
  s_waitcnt lgkmcnt(7)
  ds_read_b128 a[116:119], v16 offset:896
  v_mfma_f32_16x16x32_bf16 v[48:51], a[80:83], a[16:19], v[48:51]
  v_mfma_f32_16x16x32_bf16 v[56:59], a[80:83], a[20:23], v[56:59]
  s_add_u32 m0, s44, 64
  ds_read_b128 a[120:123], v16 offset:448
  buffer_load_dwordx4 v19, s[24:27], s42 offen offset:2048 nt lds
  v_mfma_f32_16x16x32_bf16 v[52:55], a[84:87], a[16:19], v[52:55]
  ds_read_b128 a[124:127], v16 offset:960
  v_mfma_f32_16x16x32_bf16 v[60:63], a[84:87], a[20:23], v[60:63]
  s_waitcnt lgkmcnt(8)
  ds_read_b64_tr_b16 a[128:129], v17 offset:0
  v_mfma_f32_16x16x32_bf16 v[48:51], a[88:91], a[24:27], v[48:51]
  v_mfma_f32_16x16x32_bf16 v[56:59], a[88:91], a[28:31], v[56:59]
  ds_read_b64_tr_b16 a[130:131], v17 offset:512
  v_mfma_f32_16x16x32_bf16 v[52:55], a[92:95], a[24:27], v[52:55]
  ds_read_b64_tr_b16 a[132:133], v17 offset:32
  ds_read_b64_tr_b16 a[134:135], v17 offset:544
  v_mfma_f32_16x16x32_bf16 v[60:63], a[92:95], a[28:31], v[60:63]
  s_waitcnt lgkmcnt(10)
  ds_read_b64_tr_b16 a[136:137], v17 offset:64
  v_mfma_f32_16x16x32_bf16 v[48:51], a[96:99], a[32:35], v[48:51]
  v_mfma_f32_16x16x32_bf16 v[56:59], a[96:99], a[36:39], v[56:59]
  s_add_u32 m0, s44, 96
  ds_read_b64_tr_b16 a[138:139], v17 offset:576
  buffer_load_dwordx4 v19, s[24:27], s42 offen offset:3072 nt lds
  v_mfma_f32_16x16x32_bf16 v[52:55], a[100:103], a[32:35], v[52:55]
  s_add_u32 s42, s42, 16384
  ds_read_b64_tr_b16 a[140:141], v17 offset:96
  v_mfma_f32_16x16x32_bf16 v[60:63], a[100:103], a[36:39], v[60:63]
  s_waitcnt lgkmcnt(11)
  ds_read_b64_tr_b16 a[142:143], v17 offset:608
  v_mfma_f32_16x16x32_bf16 v[48:51], a[104:107], a[40:43], v[48:51]
  v_mfma_f32_16x16x32_bf16 v[56:59], a[104:107], a[44:47], v[56:59]
  ds_read_b64_tr_b16 a[144:145], v17 offset:128
  v_mfma_f32_16x16x32_bf16 v[52:55], a[108:111], a[40:43], v[52:55]
  ds_read_b64_tr_b16 a[146:147], v17 offset:640
  v_mfma_f32_16x16x32_bf16 v[60:63], a[108:111], a[44:47], v[60:63]
  s_waitcnt lgkmcnt(12)
  ds_read_b64_tr_b16 a[148:149], v17 offset:160
  v_mfma_f32_16x16x32_bf16 v[48:51], a[112:115], a[48:51], v[48:51]
  v_mfma_f32_16x16x32_bf16 v[56:59], a[112:115], a[52:55], v[56:59]
  s_add_u32 m0, s43, 16896
  ds_read_b64_tr_b16 a[150:151], v17 offset:672
  buffer_load_dwordx4 v18, s[20:23], s41 offen offset:0 nt lds
  v_mfma_f32_16x16x32_bf16 v[52:55], a[116:119], a[48:51], v[52:55]
  ds_read_b64_tr_b16 a[152:153], v17 offset:192
  v_mfma_f32_16x16x32_bf16 v[60:63], a[116:119], a[52:55], v[60:63]
  s_waitcnt lgkmcnt(13)
  ds_read_b64_tr_b16 a[154:155], v17 offset:704
  v_mfma_f32_16x16x32_bf16 v[48:51], a[120:123], a[56:59], v[48:51]
  v_mfma_f32_16x16x32_bf16 v[56:59], a[120:123], a[60:63], v[56:59]
  ds_read_b64_tr_b16 a[156:157], v17 offset:224
  v_mfma_f32_16x16x32_bf16 v[52:55], a[124:127], a[56:59], v[52:55]
  ds_read_b64_tr_b16 a[158:159], v17 offset:736
  ds_read_b64_tr_b16 a[160:161], v17 offset:256
  v_exp_f32 v112, v96
  v_exp_f32 v113, v97
  v_add_f32 v22, v22, v112
  v_exp_f32 v114, v98
  v_add_f32 v22, v22, v113
  v_cvt_pk_bf16_f32 v32, v112, v113
  v_exp_f32 v115, v99
  v_add_f32 v22, v22, v114
  v_exp_f32 v116, v100
  v_add_f32 v22, v22, v115
  v_cvt_pk_bf16_f32 v33, v114, v115
  v_exp_f32 v117, v101
  v_add_f32 v22, v22, v116
  v_exp_f32 v118, v102
  v_add_f32 v22, v22, v117
  v_cvt_pk_bf16_f32 v34, v116, v117
  v_exp_f32 v119, v103
  v_add_f32 v22, v22, v118
  v_exp_f32 v120, v104
  v_add_f32 v22, v22, v119
  v_cvt_pk_bf16_f32 v35, v118, v119
  v_exp_f32 v121, v105
  v_add_f32 v23, v23, v120
  v_exp_f32 v122, v106
  v_add_f32 v23, v23, v121
  v_cvt_pk_bf16_f32 v36, v120, v121
  v_exp_f32 v123, v107
  v_add_f32 v23, v23, v122
  v_exp_f32 v124, v108
  v_add_f32 v23, v23, v123
  v_cvt_pk_bf16_f32 v37, v122, v123
  v_exp_f32 v125, v109
  v_add_f32 v23, v23, v124
  v_exp_f32 v126, v110
  v_add_f32 v23, v23, v125
  v_cvt_pk_bf16_f32 v38, v124, v125
  v_exp_f32 v127, v111
  v_add_f32 v23, v23, v126
  s_nop 0
  v_add_f32 v23, v23, v127
  v_cvt_pk_bf16_f32 v39, v126, v127
  v_mov_b32 v128, 0
  v_mov_b32 v129, 0
  v_mov_b32 v130, 0
  v_mov_b32 v131, 0
  v_mov_b32 v132, 0
  v_mov_b32 v133, 0
  v_mov_b32 v134, 0
  v_mov_b32 v135, 0
  v_mov_b32 v136, 0
  v_mov_b32 v137, 0
  v_mov_b32 v138, 0
  v_mov_b32 v139, 0
  v_mov_b32 v140, 0
  v_mov_b32 v141, 0
  v_mov_b32 v142, 0
  v_mov_b32 v143, 0
  v_mov_b32 v144, 0
  v_mov_b32 v145, 0
  v_mov_b32 v146, 0
  v_mov_b32 v147, 0
  v_mov_b32 v148, 0
  v_mov_b32 v149, 0
  v_mov_b32 v150, 0
  v_mov_b32 v151, 0
  v_mov_b32 v152, 0
  v_mov_b32 v153, 0
  v_mov_b32 v154, 0
  v_mov_b32 v155, 0
  v_mov_b32 v156, 0
  v_mov_b32 v157, 0
  v_mov_b32 v158, 0
  v_mov_b32 v159, 0
  v_mov_b32 v160, 0
  v_mov_b32 v161, 0
  v_mov_b32 v162, 0
  v_mov_b32 v163, 0
  v_mov_b32 v164, 0
  v_mov_b32 v165, 0
  v_mov_b32 v166, 0
  v_mov_b32 v167, 0
  v_mov_b32 v168, 0
  v_mov_b32 v169, 0
  v_mov_b32 v170, 0
  v_mov_b32 v171, 0
  v_mov_b32 v172, 0
  v_mov_b32 v173, 0
  v_mov_b32 v174, 0
  v_mov_b32 v175, 0
  v_mov_b32 v176, 0
  v_mov_b32 v177, 0
  v_mov_b32 v178, 0
  v_mov_b32 v179, 0
  v_mov_b32 v180, 0
  v_mov_b32 v181, 0
  v_mov_b32 v182, 0
  v_mov_b32 v183, 0
  v_mov_b32 v184, 0
  v_mov_b32 v185, 0
  v_mov_b32 v186, 0
  v_mov_b32 v187, 0
  v_mov_b32 v188, 0
  v_mov_b32 v189, 0
  v_mov_b32 v190, 0
  v_mov_b32 v191, 0
  v_mfma_f32_16x16x32_bf16 v[60:63], a[124:127], a[60:63], v[60:63]
  s_waitcnt lgkmcnt(13)
  ds_read_b64_tr_b16 a[162:163], v17 offset:768
  v_mfma_f32_16x16x32_bf16 v[128:131], a[128:131], v[32:35], v[128:131]
  v_mfma_f32_16x16x32_bf16 v[132:135], a[128:131], v[36:39], v[132:135]
  s_add_u32 m0, s43, 16928
  ds_read_b64_tr_b16 a[164:165], v17 offset:288
  buffer_load_dwordx4 v18, s[20:23], s41 offen offset:1024 nt lds
  v_mfma_f32_16x16x32_bf16 v[136:139], a[132:135], v[32:35], v[136:139]
  ds_read_b64_tr_b16 a[166:167], v17 offset:800
  v_mfma_f32_16x16x32_bf16 v[140:143], a[132:135], v[36:39], v[140:143]
  s_waitcnt lgkmcnt(12)
  ds_read_b64_tr_b16 a[168:169], v17 offset:320
  v_mfma_f32_16x16x32_bf16 v[144:147], a[136:139], v[32:35], v[144:147]
  v_mfma_f32_16x16x32_bf16 v[148:151], a[136:139], v[36:39], v[148:151]
  ds_read_b64_tr_b16 a[170:171], v17 offset:832
  v_mfma_f32_16x16x32_bf16 v[152:155], a[140:143], v[32:35], v[152:155]
  s_add_u32 m0, s43, 16960
  ds_read_b64_tr_b16 a[172:173], v17 offset:352
  buffer_load_dwordx4 v18, s[20:23], s41 offen offset:2048 nt lds
  v_mfma_f32_16x16x32_bf16 v[156:159], a[140:143], v[36:39], v[156:159]
  s_waitcnt lgkmcnt(11)
  ds_read_b64_tr_b16 a[174:175], v17 offset:864
  v_mfma_f32_16x16x32_bf16 v[160:163], a[144:147], v[32:35], v[160:163]
  v_mfma_f32_16x16x32_bf16 v[164:167], a[144:147], v[36:39], v[164:167]
  ds_read_b64_tr_b16 a[176:177], v17 offset:384
  v_mfma_f32_16x16x32_bf16 v[168:171], a[148:151], v[32:35], v[168:171]
  ds_read_b64_tr_b16 a[178:179], v17 offset:896
  v_mov_b32 v192, 0
  v_mov_b32 v193, 0
  v_mov_b32 v194, 0
  v_mov_b32 v195, 0
  v_mov_b32 v196, 0
  v_mov_b32 v197, 0
  v_mov_b32 v198, 0
  v_mov_b32 v199, 0
  v_mov_b32 v200, 0
  v_mov_b32 v201, 0
  v_mov_b32 v202, 0
  v_mov_b32 v203, 0
  v_mov_b32 v204, 0
  v_mov_b32 v205, 0
  v_mov_b32 v206, 0
  v_mov_b32 v207, 0
  v_mov_b32 v208, 0
  v_mov_b32 v209, 0
  v_mov_b32 v210, 0
  v_mov_b32 v211, 0
  v_mov_b32 v212, 0
  v_mov_b32 v213, 0
  v_mov_b32 v214, 0
  v_mov_b32 v215, 0
  v_mov_b32 v216, 0
  v_mov_b32 v217, 0
  v_mov_b32 v218, 0
  v_mov_b32 v219, 0
  v_mov_b32 v220, 0
  v_mov_b32 v221, 0
  v_mov_b32 v222, 0
  v_mov_b32 v223, 0
  v_mov_b32 v224, 0
  v_mov_b32 v225, 0
  v_mov_b32 v226, 0
  v_mov_b32 v227, 0
  v_mov_b32 v228, 0
  v_mov_b32 v229, 0
  v_mov_b32 v230, 0
  v_mov_b32 v231, 0
  v_mov_b32 v232, 0
  v_mov_b32 v233, 0
  v_mov_b32 v234, 0
  v_mov_b32 v235, 0
  v_mov_b32 v236, 0
  v_mov_b32 v237, 0
  v_mov_b32 v238, 0
  v_mov_b32 v239, 0
  v_mov_b32 v240, 0
  v_mov_b32 v241, 0
  v_mov_b32 v242, 0
  v_mov_b32 v243, 0
  v_mov_b32 v244, 0
  v_mov_b32 v245, 0
  v_mov_b32 v246, 0
  v_mov_b32 v247, 0
  v_mov_b32 v248, 0
  v_mov_b32 v249, 0
  v_mov_b32 v250, 0
  v_mov_b32 v251, 0
  v_mov_b32 v252, 0
  v_mov_b32 v253, 0
  v_mov_b32 v254, 0
  v_mov_b32 v255, 0
  v_mfma_f32_16x16x32_bf16 v[172:175], a[148:151], v[36:39], v[172:175]
  s_waitcnt lgkmcnt(10)
  v_mfma_f32_16x16x32_bf16 v[176:179], a[152:155], v[32:35], v[176:179]
  ds_read_b64_tr_b16 a[180:181], v17 offset:416
  v_mfma_f32_16x16x32_bf16 v[180:183], a[152:155], v[36:39], v[180:183]
  s_add_u32 m0, s43, 16992
  ds_read_b64_tr_b16 a[182:183], v17 offset:928
  buffer_load_dwordx4 v18, s[20:23], s41 offen offset:3072 nt lds
  v_mfma_f32_16x16x32_bf16 v[184:187], a[156:159], v[32:35], v[184:187]
  s_add_u32 s41, s41, 16384
  v_mfma_f32_16x16x32_bf16 v[188:191], a[156:159], v[36:39], v[188:191]
  s_waitcnt lgkmcnt(8)
  ds_read_b64_tr_b16 a[184:185], v17 offset:448
  v_mfma_f32_16x16x32_bf16 v[192:195], a[160:163], v[32:35], v[192:195]
  s_waitcnt vmcnt(12)
  ds_read_b64_tr_b16 a[186:187], v17 offset:960
  v_mfma_f32_16x16x32_bf16 v[196:199], a[160:163], v[36:39], v[196:199]
  s_barrier
  v_mfma_f32_16x16x32_bf16 v[200:203], a[164:167], v[32:35], v[200:203]
  s_add_u32 s43, s43, s55
  v_mfma_f32_16x16x32_bf16 v[204:207], a[164:167], v[36:39], v[204:207]
  s_waitcnt lgkmcnt(6)
  ds_read_b64_tr_b16 a[188:189], v17 offset:480
  v_mfma_f32_16x16x32_bf16 v[208:211], a[168:171], v[32:35], v[208:211]
  s_sub_u32 s55, 0, s55
  ds_read_b64_tr_b16 a[190:191], v17 offset:992
  v_mfma_f32_16x16x32_bf16 v[212:215], a[168:171], v[36:39], v[212:215]
  v_mfma_f32_16x16x32_bf16 v[216:219], a[172:175], v[32:35], v[216:219]
  s_add_u32 m0, s44, 16896
  ds_read_b128 a[64:67], v16 offset:16896
  buffer_load_dwordx4 v19, s[24:27], s42 offen offset:0 nt lds
  v_mfma_f32_16x16x32_bf16 v[220:223], a[172:175], v[36:39], v[220:223]
  s_waitcnt lgkmcnt(5)
  ds_read_b128 a[68:71], v16 offset:17408
  v_mfma_f32_16x16x32_bf16 v[224:227], a[176:179], v[32:35], v[224:227]
  v_mfma_f32_16x16x32_bf16 v[228:231], a[176:179], v[36:39], v[228:231]
  ds_read_b128 a[72:75], v16 offset:16960
  v_mfma_f32_16x16x32_bf16 v[232:235], a[180:183], v[32:35], v[232:235]
  ds_read_b128 a[76:79], v16 offset:17472
  v_mfma_f32_16x16x32_bf16 v[236:239], a[180:183], v[36:39], v[236:239]
  s_waitcnt lgkmcnt(4)
  ds_read_b128 a[80:83], v16 offset:17024
  v_mfma_f32_16x16x32_bf16 v[240:243], a[184:187], v[32:35], v[240:243]
  ds_read_b128 a[84:87], v16 offset:17536
  v_add_f32 v22, v22, v8
  v_add_f32 v23, v23, v9
  v_exp_f32 v80, v64
  v_exp_f32 v81, v65
  v_exp_f32 v82, v66
  v_add_f32 v8, v80, v81
  v_cvt_pk_bf16_f32 v40, v80, v81
  v_exp_f32 v83, v67
  v_add_f32 v8, v8, v82
  v_exp_f32 v84, v68
  v_add_f32 v8, v8, v83
  v_cvt_pk_bf16_f32 v41, v82, v83
  v_exp_f32 v85, v69
  v_add_f32 v8, v8, v84
  v_exp_f32 v86, v70
  v_add_f32 v8, v8, v85
  v_cvt_pk_bf16_f32 v42, v84, v85
  v_exp_f32 v87, v71
  v_add_f32 v8, v8, v86
  v_exp_f32 v88, v72
  v_add_f32 v8, v8, v87
  v_cvt_pk_bf16_f32 v43, v86, v87
  v_exp_f32 v89, v73
  v_exp_f32 v90, v74
  v_add_f32 v9, v88, v89
  v_cvt_pk_bf16_f32 v44, v88, v89
  v_exp_f32 v91, v75
  v_add_f32 v9, v9, v90
  v_exp_f32 v92, v76
  v_add_f32 v9, v9, v91
  v_cvt_pk_bf16_f32 v45, v90, v91
  v_exp_f32 v93, v77
  v_add_f32 v9, v9, v92
  v_exp_f32 v94, v78
  v_add_f32 v9, v9, v93
  v_cvt_pk_bf16_f32 v46, v92, v93
  v_exp_f32 v95, v79
  v_add_f32 v9, v9, v94
  v_add_f32 v9, v9, v95
  v_cvt_pk_bf16_f32 v47, v94, v95
  v_max_f32 v20, v8, v9
  v_cmp_lt_f32 vcc, s60, v20
  v_mfma_f32_16x16x32_bf16 v[244:247], a[184:187], v[36:39], v[244:247]
  ds_read_b128 a[88:91], v16 offset:17088
  v_mfma_f32_16x16x32_bf16 v[248:251], a[188:191], v[32:35], v[248:251]
  s_waitcnt lgkmcnt(5)
  ds_read_b128 a[92:95], v16 offset:17600
  v_mfma_f32_16x16x32_bf16 v[252:255], a[188:191], v[36:39], v[252:255]
  s_cbranch_vccnz L_rare5
L_back5:
  v_mfma_f32_16x16x32_bf16 v[64:67], a[64:67], a[0:3], v[24:27]
  v_mfma_f32_16x16x32_bf16 v[72:75], a[64:67], a[4:7], v[28:31]
  ds_read_b128 a[96:99], v16 offset:17152
  v_mfma_f32_16x16x32_bf16 v[68:71], a[68:71], a[0:3], v[24:27]
  s_add_u32 m0, s44, 16928
  ds_read_b128 a[100:103], v16 offset:17664
  buffer_load_dwordx4 v19, s[24:27], s42 offen offset:1024 nt lds
  v_mfma_f32_16x16x32_bf16 v[76:79], a[68:71], a[4:7], v[28:31]
  s_waitcnt lgkmcnt(6)
  ds_read_b128 a[104:107], v16 offset:17216
  v_mfma_f32_16x16x32_bf16 v[64:67], a[72:75], a[8:11], v[64:67]
  v_mfma_f32_16x16x32_bf16 v[72:75], a[72:75], a[12:15], v[72:75]
  ds_read_b128 a[108:111], v16 offset:17728
  v_mfma_f32_16x16x32_bf16 v[68:71], a[76:79], a[8:11], v[68:71]
  ds_read_b128 a[112:115], v16 offset:17280
  v_mfma_f32_16x16x32_bf16 v[76:79], a[76:79], a[12:15], v[76:79]
  s_waitcnt lgkmcnt(7)
  ds_read_b128 a[116:119], v16 offset:17792
  v_mfma_f32_16x16x32_bf16 v[64:67], a[80:83], a[16:19], v[64:67]
  v_mfma_f32_16x16x32_bf16 v[72:75], a[80:83], a[20:23], v[72:75]
  s_add_u32 m0, s44, 16960
  ds_read_b128 a[120:123], v16 offset:17344
  buffer_load_dwordx4 v19, s[24:27], s42 offen offset:2048 nt lds
  v_mfma_f32_16x16x32_bf16 v[68:71], a[84:87], a[16:19], v[68:71]
  ds_read_b128 a[124:127], v16 offset:17856
  v_add_u32 v16, s47, v16
  v_mfma_f32_16x16x32_bf16 v[76:79], a[84:87], a[20:23], v[76:79]
  s_waitcnt lgkmcnt(8)
  ds_read_b64_tr_b16 a[128:129], v17 offset:16896
  v_mfma_f32_16x16x32_bf16 v[64:67], a[88:91], a[24:27], v[64:67]
  s_sub_u32 s47, 0, s47
  v_mfma_f32_16x16x32_bf16 v[72:75], a[88:91], a[28:31], v[72:75]
  ds_read_b64_tr_b16 a[130:131], v17 offset:17408
  v_mfma_f32_16x16x32_bf16 v[68:71], a[92:95], a[24:27], v[68:71]
  ds_read_b64_tr_b16 a[132:133], v17 offset:16928
  ds_read_b64_tr_b16 a[134:135], v17 offset:17440
  v_mfma_f32_16x16x32_bf16 v[76:79], a[92:95], a[28:31], v[76:79]
  s_waitcnt lgkmcnt(10)
  ds_read_b64_tr_b16 a[136:137], v17 offset:16960
  v_mfma_f32_16x16x32_bf16 v[64:67], a[96:99], a[32:35], v[64:67]
  v_mfma_f32_16x16x32_bf16 v[72:75], a[96:99], a[36:39], v[72:75]
  s_add_u32 m0, s44, 16992
  ds_read_b64_tr_b16 a[138:139], v17 offset:17472
  buffer_load_dwordx4 v19, s[24:27], s42 offen offset:3072 nt lds
  v_mfma_f32_16x16x32_bf16 v[68:71], a[100:103], a[32:35], v[68:71]
  s_add_u32 s42, s42, 16384
  ds_read_b64_tr_b16 a[140:141], v17 offset:16992
  v_mfma_f32_16x16x32_bf16 v[76:79], a[100:103], a[36:39], v[76:79]
  s_waitcnt lgkmcnt(11)
  ds_read_b64_tr_b16 a[142:143], v17 offset:17504
  v_mfma_f32_16x16x32_bf16 v[64:67], a[104:107], a[40:43], v[64:67]
  s_add_u32 s44, s44, s56
  v_mfma_f32_16x16x32_bf16 v[72:75], a[104:107], a[44:47], v[72:75]
  s_sub_u32 s56, 0, s56
  ds_read_b64_tr_b16 a[144:145], v17 offset:17024
  v_mfma_f32_16x16x32_bf16 v[68:71], a[108:111], a[40:43], v[68:71]
  ds_read_b64_tr_b16 a[146:147], v17 offset:17536
  v_mfma_f32_16x16x32_bf16 v[76:79], a[108:111], a[44:47], v[76:79]
  s_waitcnt lgkmcnt(12)
  ds_read_b64_tr_b16 a[148:149], v17 offset:17056
  v_mfma_f32_16x16x32_bf16 v[64:67], a[112:115], a[48:51], v[64:67]
  v_mfma_f32_16x16x32_bf16 v[72:75], a[112:115], a[52:55], v[72:75]
  s_add_u32 m0, s43, 0
  ds_read_b64_tr_b16 a[150:151], v17 offset:17568
  buffer_load_dwordx4 v18, s[20:23], s41 offen offset:0 nt lds
  v_mfma_f32_16x16x32_bf16 v[68:71], a[116:119], a[48:51], v[68:71]
  ds_read_b64_tr_b16 a[152:153], v17 offset:17088
  v_mfma_f32_16x16x32_bf16 v[76:79], a[116:119], a[52:55], v[76:79]
  s_waitcnt lgkmcnt(13)
  ds_read_b64_tr_b16 a[154:155], v17 offset:17600
  v_mfma_f32_16x16x32_bf16 v[64:67], a[120:123], a[56:59], v[64:67]
  v_mfma_f32_16x16x32_bf16 v[72:75], a[120:123], a[60:63], v[72:75]
  ds_read_b64_tr_b16 a[156:157], v17 offset:17120
  v_mfma_f32_16x16x32_bf16 v[68:71], a[124:127], a[56:59], v[68:71]
  ds_read_b64_tr_b16 a[158:159], v17 offset:17632
  ds_read_b64_tr_b16 a[160:161], v17 offset:17152
  v_mfma_f32_16x16x32_bf16 v[76:79], a[124:127], a[60:63], v[76:79]
  s_waitcnt lgkmcnt(13)
  ds_read_b64_tr_b16 a[162:163], v17 offset:17664
  v_mfma_f32_16x16x32_bf16 v[128:131], a[128:131], v[40:43], v[128:131]
  v_mfma_f32_16x16x32_bf16 v[132:135], a[128:131], v[44:47], v[132:135]
  s_add_u32 m0, s43, 32
  ds_read_b64_tr_b16 a[164:165], v17 offset:17184
  buffer_load_dwordx4 v18, s[20:23], s41 offen offset:1024 nt lds
  v_mfma_f32_16x16x32_bf16 v[136:139], a[132:135], v[40:43], v[136:139]
  ds_read_b64_tr_b16 a[166:167], v17 offset:17696
  v_mfma_f32_16x16x32_bf16 v[140:143], a[132:135], v[44:47], v[140:143]
  s_waitcnt lgkmcnt(12)
  ds_read_b64_tr_b16 a[168:169], v17 offset:17216
  v_mfma_f32_16x16x32_bf16 v[144:147], a[136:139], v[40:43], v[144:147]
  v_mfma_f32_16x16x32_bf16 v[148:151], a[136:139], v[44:47], v[148:151]
  ds_read_b64_tr_b16 a[170:171], v17 offset:17728
  v_mfma_f32_16x16x32_bf16 v[152:155], a[140:143], v[40:43], v[152:155]
  s_add_u32 m0, s43, 64
  ds_read_b64_tr_b16 a[172:173], v17 offset:17248
  buffer_load_dwordx4 v18, s[20:23], s41 offen offset:2048 nt lds
  v_mfma_f32_16x16x32_bf16 v[156:159], a[140:143], v[44:47], v[156:159]
  s_waitcnt lgkmcnt(11)
  ds_read_b64_tr_b16 a[174:175], v17 offset:17760
  v_mfma_f32_16x16x32_bf16 v[160:163], a[144:147], v[40:43], v[160:163]
  v_mfma_f32_16x16x32_bf16 v[164:167], a[144:147], v[44:47], v[164:167]
  ds_read_b64_tr_b16 a[176:177], v17 offset:17280
  v_mfma_f32_16x16x32_bf16 v[168:171], a[148:151], v[40:43], v[168:171]
  ds_read_b64_tr_b16 a[178:179], v17 offset:17792
  v_mfma_f32_16x16x32_bf16 v[172:175], a[148:151], v[44:47], v[172:175]
  s_waitcnt lgkmcnt(10)
  v_mfma_f32_16x16x32_bf16 v[176:179], a[152:155], v[40:43], v[176:179]
  ds_read_b64_tr_b16 a[180:181], v17 offset:17312
  v_mfma_f32_16x16x32_bf16 v[180:183], a[152:155], v[44:47], v[180:183]
  s_add_u32 m0, s43, 96
  ds_read_b64_tr_b16 a[182:183], v17 offset:17824
  buffer_load_dwordx4 v18, s[20:23], s41 offen offset:3072 nt lds
  v_mfma_f32_16x16x32_bf16 v[184:187], a[156:159], v[40:43], v[184:187]
  s_add_u32 s41, s41, 16384
  v_mfma_f32_16x16x32_bf16 v[188:191], a[156:159], v[44:47], v[188:191]
  s_waitcnt lgkmcnt(8)
  ds_read_b64_tr_b16 a[184:185], v17 offset:17344
  v_mfma_f32_16x16x32_bf16 v[192:195], a[160:163], v[40:43], v[192:195]
  s_waitcnt vmcnt(12)
  ds_read_b64_tr_b16 a[186:187], v17 offset:17856
  v_mfma_f32_16x16x32_bf16 v[196:199], a[160:163], v[44:47], v[196:199]
  s_barrier
  v_mfma_f32_16x16x32_bf16 v[200:203], a[164:167], v[40:43], v[200:203]
  v_mfma_f32_16x16x32_bf16 v[204:207], a[164:167], v[44:47], v[204:207]
  s_waitcnt lgkmcnt(6)
  ds_read_b64_tr_b16 a[188:189], v17 offset:17376
  v_mfma_f32_16x16x32_bf16 v[208:211], a[168:171], v[40:43], v[208:211]
  ds_read_b64_tr_b16 a[190:191], v17 offset:17888
  v_add_u32 v17, s48, v17
  v_mfma_f32_16x16x32_bf16 v[212:215], a[168:171], v[44:47], v[212:215]
  s_sub_u32 s48, 0, s48
  v_mfma_f32_16x16x32_bf16 v[216:219], a[172:175], v[40:43], v[216:219]
  s_add_u32 m0, s44, 0
  ds_read_b128 a[64:67], v16 offset:0
  buffer_load_dwordx4 v19, s[24:27], s42 offen offset:0 nt lds
  v_mfma_f32_16x16x32_bf16 v[220:223], a[172:175], v[44:47], v[220:223]
  s_waitcnt lgkmcnt(5)
  ds_read_b128 a[68:71], v16 offset:512
  v_mfma_f32_16x16x32_bf16 v[224:227], a[176:179], v[40:43], v[224:227]
  v_mfma_f32_16x16x32_bf16 v[228:231], a[176:179], v[44:47], v[228:231]
  ds_read_b128 a[72:75], v16 offset:64
  v_mfma_f32_16x16x32_bf16 v[232:235], a[180:183], v[40:43], v[232:235]
  ds_read_b128 a[76:79], v16 offset:576
  v_mfma_f32_16x16x32_bf16 v[236:239], a[180:183], v[44:47], v[236:239]
  s_waitcnt lgkmcnt(4)
  ds_read_b128 a[80:83], v16 offset:128
  v_mfma_f32_16x16x32_bf16 v[240:243], a[184:187], v[40:43], v[240:243]
  ds_read_b128 a[84:87], v16 offset:640
  v_add_f32 v22, v22, v8
  v_add_f32 v23, v23, v9
  v_exp_f32 v80, v48
  v_exp_f32 v81, v49
  v_exp_f32 v82, v50
  v_add_f32 v8, v80, v81
  v_cvt_pk_bf16_f32 v32, v80, v81
  v_exp_f32 v83, v51
  v_add_f32 v8, v8, v82
  v_exp_f32 v84, v52
  v_add_f32 v8, v8, v83
  v_cvt_pk_bf16_f32 v33, v82, v83
  v_exp_f32 v85, v53
  v_add_f32 v8, v8, v84
  v_exp_f32 v86, v54
  v_add_f32 v8, v8, v85
  v_cvt_pk_bf16_f32 v34, v84, v85
  v_exp_f32 v87, v55
  v_add_f32 v8, v8, v86
  v_exp_f32 v88, v56
  v_add_f32 v8, v8, v87
  v_cvt_pk_bf16_f32 v35, v86, v87
  v_exp_f32 v89, v57
  v_exp_f32 v90, v58
  v_add_f32 v9, v88, v89
  v_cvt_pk_bf16_f32 v36, v88, v89
  v_exp_f32 v91, v59
  v_add_f32 v9, v9, v90
  v_exp_f32 v92, v60
  v_add_f32 v9, v9, v91
  v_cvt_pk_bf16_f32 v37, v90, v91
  v_exp_f32 v93, v61
  v_add_f32 v9, v9, v92
  v_exp_f32 v94, v62
  v_add_f32 v9, v9, v93
  v_cvt_pk_bf16_f32 v38, v92, v93
  v_exp_f32 v95, v63
  v_add_f32 v9, v9, v94
  v_add_f32 v9, v9, v95
  v_cvt_pk_bf16_f32 v39, v94, v95
  v_max_f32 v20, v8, v9
  v_cmp_lt_f32 vcc, s60, v20
  v_mfma_f32_16x16x32_bf16 v[244:247], a[184:187], v[44:47], v[244:247]
  ds_read_b128 a[88:91], v16 offset:192
  v_mfma_f32_16x16x32_bf16 v[248:251], a[188:191], v[40:43], v[248:251]
  s_waitcnt lgkmcnt(5)
  ds_read_b128 a[92:95], v16 offset:704
  v_mfma_f32_16x16x32_bf16 v[252:255], a[188:191], v[44:47], v[252:255]
  s_cbranch_vccnz L_rare6
L_back6:
  v_mfma_f32_16x16x32_bf16 v[48:51], a[64:67], a[0:3], v[24:27]
  v_mfma_f32_16x16x32_bf16 v[56:59], a[64:67], a[4:7], v[28:31]
  ds_read_b128 a[96:99], v16 offset:256
  v_mfma_f32_16x16x32_bf16 v[52:55], a[68:71], a[0:3], v[24:27]
  s_add_u32 m0, s44, 32
  ds_read_b128 a[100:103], v16 offset:768
  buffer_load_dwordx4 v19, s[24:27], s42 offen offset:1024 nt lds
  v_mfma_f32_16x16x32_bf16 v[60:63], a[68:71], a[4:7], v[28:31]
  s_waitcnt lgkmcnt(6)
  ds_read_b128 a[104:107], v16 offset:320
  v_mfma_f32_16x16x32_bf16 v[48:51], a[72:75], a[8:11], v[48:51]
  v_mfma_f32_16x16x32_bf16 v[56:59], a[72:75], a[12:15], v[56:59]
  ds_read_b128 a[108:111], v16 offset:832
  v_mfma_f32_16x16x32_bf16 v[52:55], a[76:79], a[8:11], v[52:55]
  ds_read_b128 a[112:115], v16 offset:384
  v_mfma_f32_16x16x32_bf16 v[60:63], a[76:79], a[12:15], v[60:63]
  s_waitcnt lgkmcnt(7)
  ds_read_b128 a[116:119], v16 offset:896
  v_mfma_f32_16x16x32_bf16 v[48:51], a[80:83], a[16:19], v[48:51]
  v_mfma_f32_16x16x32_bf16 v[56:59], a[80:83], a[20:23], v[56:59]
  s_add_u32 m0, s44, 64
  ds_read_b128 a[120:123], v16 offset:448
  buffer_load_dwordx4 v19, s[24:27], s42 offen offset:2048 nt lds
  v_mfma_f32_16x16x32_bf16 v[52:55], a[84:87], a[16:19], v[52:55]
  ds_read_b128 a[124:127], v16 offset:960
  v_mfma_f32_16x16x32_bf16 v[60:63], a[84:87], a[20:23], v[60:63]
  s_waitcnt lgkmcnt(8)
  ds_read_b64_tr_b16 a[128:129], v17 offset:0
  v_mfma_f32_16x16x32_bf16 v[48:51], a[88:91], a[24:27], v[48:51]
  v_mfma_f32_16x16x32_bf16 v[56:59], a[88:91], a[28:31], v[56:59]
  ds_read_b64_tr_b16 a[130:131], v17 offset:512
  v_mfma_f32_16x16x32_bf16 v[52:55], a[92:95], a[24:27], v[52:55]
  ds_read_b64_tr_b16 a[132:133], v17 offset:32
  ds_read_b64_tr_b16 a[134:135], v17 offset:544
  v_mfma_f32_16x16x32_bf16 v[60:63], a[92:95], a[28:31], v[60:63]
  s_waitcnt lgkmcnt(10)
  ds_read_b64_tr_b16 a[136:137], v17 offset:64
  v_mfma_f32_16x16x32_bf16 v[48:51], a[96:99], a[32:35], v[48:51]
  v_mfma_f32_16x16x32_bf16 v[56:59], a[96:99], a[36:39], v[56:59]
  s_add_u32 m0, s44, 96
  ds_read_b64_tr_b16 a[138:139], v17 offset:576
  buffer_load_dwordx4 v19, s[24:27], s42 offen offset:3072 nt lds
  v_mfma_f32_16x16x32_bf16 v[52:55], a[100:103], a[32:35], v[52:55]
  s_add_u32 s42, s42, 16384
  ds_read_b64_tr_b16 a[140:141], v17 offset:96
  v_mfma_f32_16x16x32_bf16 v[60:63], a[100:103], a[36:39], v[60:63]
  s_waitcnt lgkmcnt(11)
  ds_read_b64_tr_b16 a[142:143], v17 offset:608
  v_mfma_f32_16x16x32_bf16 v[48:51], a[104:107], a[40:43], v[48:51]
  v_mfma_f32_16x16x32_bf16 v[56:59], a[104:107], a[44:47], v[56:59]
  ds_read_b64_tr_b16 a[144:145], v17 offset:128
  v_mfma_f32_16x16x32_bf16 v[52:55], a[108:111], a[40:43], v[52:55]
  ds_read_b64_tr_b16 a[146:147], v17 offset:640
  v_mfma_f32_16x16x32_bf16 v[60:63], a[108:111], a[44:47], v[60:63]
  s_waitcnt lgkmcnt(12)
  ds_read_b64_tr_b16 a[148:149], v17 offset:160
  v_mfma_f32_16x16x32_bf16 v[48:51], a[112:115], a[48:51], v[48:51]
  v_mfma_f32_16x16x32_bf16 v[56:59], a[112:115], a[52:55], v[56:59]
  s_add_u32 m0, s43, 16896
  ds_read_b64_tr_b16 a[150:151], v17 offset:672
  buffer_load_dwordx4 v18, s[20:23], s41 offen offset:0 nt lds
  v_mfma_f32_16x16x32_bf16 v[52:55], a[116:119], a[48:51], v[52:55]
  ds_read_b64_tr_b16 a[152:153], v17 offset:192
  v_mfma_f32_16x16x32_bf16 v[60:63], a[116:119], a[52:55], v[60:63]
  s_waitcnt lgkmcnt(13)
  ds_read_b64_tr_b16 a[154:155], v17 offset:704
  v_mfma_f32_16x16x32_bf16 v[48:51], a[120:123], a[56:59], v[48:51]
  v_mfma_f32_16x16x32_bf16 v[56:59], a[120:123], a[60:63], v[56:59]
  ds_read_b64_tr_b16 a[156:157], v17 offset:224
  v_mfma_f32_16x16x32_bf16 v[52:55], a[124:127], a[56:59], v[52:55]
  ds_read_b64_tr_b16 a[158:159], v17 offset:736
  ds_read_b64_tr_b16 a[160:161], v17 offset:256
  v_mfma_f32_16x16x32_bf16 v[60:63], a[124:127], a[60:63], v[60:63]
  s_waitcnt lgkmcnt(13)
  ds_read_b64_tr_b16 a[162:163], v17 offset:768
  v_mfma_f32_16x16x32_bf16 v[128:131], a[128:131], v[32:35], v[128:131]
  v_mfma_f32_16x16x32_bf16 v[132:135], a[128:131], v[36:39], v[132:135]
  s_add_u32 m0, s43, 16928
  ds_read_b64_tr_b16 a[164:165], v17 offset:288
  buffer_load_dwordx4 v18, s[20:23], s41 offen offset:1024 nt lds
  v_mfma_f32_16x16x32_bf16 v[136:139], a[132:135], v[32:35], v[136:139]
  ds_read_b64_tr_b16 a[166:167], v17 offset:800
  v_mfma_f32_16x16x32_bf16 v[140:143], a[132:135], v[36:39], v[140:143]
  s_waitcnt lgkmcnt(12)
  ds_read_b64_tr_b16 a[168:169], v17 offset:320
  v_mfma_f32_16x16x32_bf16 v[144:147], a[136:139], v[32:35], v[144:147]
  v_mfma_f32_16x16x32_bf16 v[148:151], a[136:139], v[36:39], v[148:151]
  ds_read_b64_tr_b16 a[170:171], v17 offset:832
  v_mfma_f32_16x16x32_bf16 v[152:155], a[140:143], v[32:35], v[152:155]
  s_add_u32 m0, s43, 16960
  ds_read_b64_tr_b16 a[172:173], v17 offset:352
  buffer_load_dwordx4 v18, s[20:23], s41 offen offset:2048 nt lds
  v_mfma_f32_16x16x32_bf16 v[156:159], a[140:143], v[36:39], v[156:159]
  s_waitcnt lgkmcnt(11)
  ds_read_b64_tr_b16 a[174:175], v17 offset:864
  v_mfma_f32_16x16x32_bf16 v[160:163], a[144:147], v[32:35], v[160:163]
  v_mfma_f32_16x16x32_bf16 v[164:167], a[144:147], v[36:39], v[164:167]
  ds_read_b64_tr_b16 a[176:177], v17 offset:384
  v_mfma_f32_16x16x32_bf16 v[168:171], a[148:151], v[32:35], v[168:171]
  ds_read_b64_tr_b16 a[178:179], v17 offset:896
  v_mfma_f32_16x16x32_bf16 v[172:175], a[148:151], v[36:39], v[172:175]
  s_waitcnt lgkmcnt(10)
  v_mfma_f32_16x16x32_bf16 v[176:179], a[152:155], v[32:35], v[176:179]
  ds_read_b64_tr_b16 a[180:181], v17 offset:416
  v_mfma_f32_16x16x32_bf16 v[180:183], a[152:155], v[36:39], v[180:183]
  s_add_u32 m0, s43, 16992
  ds_read_b64_tr_b16 a[182:183], v17 offset:928
  buffer_load_dwordx4 v18, s[20:23], s41 offen offset:3072 nt lds
  v_mfma_f32_16x16x32_bf16 v[184:187], a[156:159], v[32:35], v[184:187]
  s_add_u32 s41, s41, 16384
  v_mfma_f32_16x16x32_bf16 v[188:191], a[156:159], v[36:39], v[188:191]
  s_waitcnt lgkmcnt(8)
  ds_read_b64_tr_b16 a[184:185], v17 offset:448
  v_mfma_f32_16x16x32_bf16 v[192:195], a[160:163], v[32:35], v[192:195]
  s_waitcnt vmcnt(12)
  ds_read_b64_tr_b16 a[186:187], v17 offset:960
  v_mfma_f32_16x16x32_bf16 v[196:199], a[160:163], v[36:39], v[196:199]
  s_barrier
  v_mfma_f32_16x16x32_bf16 v[200:203], a[164:167], v[32:35], v[200:203]
  s_add_u32 s43, s43, s55
  v_mfma_f32_16x16x32_bf16 v[204:207], a[164:167], v[36:39], v[204:207]
  s_waitcnt lgkmcnt(6)
  ds_read_b64_tr_b16 a[188:189], v17 offset:480
  v_mfma_f32_16x16x32_bf16 v[208:211], a[168:171], v[32:35], v[208:211]
  s_sub_u32 s55, 0, s55
  ds_read_b64_tr_b16 a[190:191], v17 offset:992
  v_mfma_f32_16x16x32_bf16 v[212:215], a[168:171], v[36:39], v[212:215]
  v_mfma_f32_16x16x32_bf16 v[216:219], a[172:175], v[32:35], v[216:219]
  s_add_u32 m0, s44, 16896
  ds_read_b128 a[64:67], v16 offset:16896
  buffer_load_dwordx4 v19, s[24:27], s42 offen offset:0 nt lds
  v_mfma_f32_16x16x32_bf16 v[220:223], a[172:175], v[36:39], v[220:223]
  s_waitcnt lgkmcnt(5)
  ds_read_b128 a[68:71], v16 offset:17408
  v_mfma_f32_16x16x32_bf16 v[224:227], a[176:179], v[32:35], v[224:227]
  v_mfma_f32_16x16x32_bf16 v[228:231], a[176:179], v[36:39], v[228:231]
  ds_read_b128 a[72:75], v16 offset:16960
  v_mfma_f32_16x16x32_bf16 v[232:235], a[180:183], v[32:35], v[232:235]
  ds_read_b128 a[76:79], v16 offset:17472
  v_mfma_f32_16x16x32_bf16 v[236:239], a[180:183], v[36:39], v[236:239]
  s_waitcnt lgkmcnt(4)
  ds_read_b128 a[80:83], v16 offset:17024
  v_mfma_f32_16x16x32_bf16 v[240:243], a[184:187], v[32:35], v[240:243]
  ds_read_b128 a[84:87], v16 offset:17536
  v_add_f32 v22, v22, v8
  v_add_f32 v23, v23, v9
  v_exp_f32 v80, v64
  v_exp_f32 v81, v65
  v_exp_f32 v82, v66
  v_add_f32 v8, v80, v81
  v_cvt_pk_bf16_f32 v40, v80, v81
  v_exp_f32 v83, v67
  v_add_f32 v8, v8, v82
  v_exp_f32 v84, v68
  v_add_f32 v8, v8, v83
  v_cvt_pk_bf16_f32 v41, v82, v83
  v_exp_f32 v85, v69
  v_add_f32 v8, v8, v84
  v_exp_f32 v86, v70
  v_add_f32 v8, v8, v85
  v_cvt_pk_bf16_f32 v42, v84, v85
  v_exp_f32 v87, v71
  v_add_f32 v8, v8, v86
  v_exp_f32 v88, v72
  v_add_f32 v8, v8, v87
  v_cvt_pk_bf16_f32 v43, v86, v87
  v_exp_f32 v89, v73
  v_exp_f32 v90, v74
  v_add_f32 v9, v88, v89
  v_cvt_pk_bf16_f32 v44, v88, v89
  v_exp_f32 v91, v75
  v_add_f32 v9, v9, v90
  v_exp_f32 v92, v76
  v_add_f32 v9, v9, v91
  v_cvt_pk_bf16_f32 v45, v90, v91
  v_exp_f32 v93, v77
  v_add_f32 v9, v9, v92
  v_exp_f32 v94, v78
  v_add_f32 v9, v9, v93
  v_cvt_pk_bf16_f32 v46, v92, v93
  v_exp_f32 v95, v79
  v_add_f32 v9, v9, v94
  v_add_f32 v9, v9, v95
  v_cvt_pk_bf16_f32 v47, v94, v95
  v_max_f32 v20, v8, v9
  v_cmp_lt_f32 vcc, s60, v20
  v_mfma_f32_16x16x32_bf16 v[244:247], a[184:187], v[36:39], v[244:247]
  ds_read_b128 a[88:91], v16 offset:17088
  v_mfma_f32_16x16x32_bf16 v[248:251], a[188:191], v[32:35], v[248:251]
  s_waitcnt lgkmcnt(5)
  ds_read_b128 a[92:95], v16 offset:17600
  v_mfma_f32_16x16x32_bf16 v[252:255], a[188:191], v[36:39], v[252:255]
  s_cbranch_vccnz L_rare7
L_back7:
  v_mfma_f32_16x16x32_bf16 v[64:67], a[64:67], a[0:3], v[24:27]
  v_mfma_f32_16x16x32_bf16 v[72:75], a[64:67], a[4:7], v[28:31]
  ds_read_b128 a[96:99], v16 offset:17152
  v_mfma_f32_16x16x32_bf16 v[68:71], a[68:71], a[0:3], v[24:27]
  s_add_u32 m0, s44, 16928
  ds_read_b128 a[100:103], v16 offset:17664
  buffer_load_dwordx4 v19, s[24:27], s42 offen offset:1024 nt lds
  v_mfma_f32_16x16x32_bf16 v[76:79], a[68:71], a[4:7], v[28:31]
  s_waitcnt lgkmcnt(6)
  ds_read_b128 a[104:107], v16 offset:17216
  v_mfma_f32_16x16x32_bf16 v[64:67], a[72:75], a[8:11], v[64:67]
  v_mfma_f32_16x16x32_bf16 v[72:75], a[72:75], a[12:15], v[72:75]
  ds_read_b128 a[108:111], v16 offset:17728
  v_mfma_f32_16x16x32_bf16 v[68:71], a[76:79], a[8:11], v[68:71]
  ds_read_b128 a[112:115], v16 offset:17280
  v_mfma_f32_16x16x32_bf16 v[76:79], a[76:79], a[12:15], v[76:79]
  s_waitcnt lgkmcnt(7)
  ds_read_b128 a[116:119], v16 offset:17792
  v_mfma_f32_16x16x32_bf16 v[64:67], a[80:83], a[16:19], v[64:67]
  v_mfma_f32_16x16x32_bf16 v[72:75], a[80:83], a[20:23], v[72:75]
  s_add_u32 m0, s44, 16960
  ds_read_b128 a[120:123], v16 offset:17344
  buffer_load_dwordx4 v19, s[24:27], s42 offen offset:2048 nt lds
  v_mfma_f32_16x16x32_bf16 v[68:71], a[84:87], a[16:19], v[68:71]
  ds_read_b128 a[124:127], v16 offset:17856
  v_add_u32 v16, s47, v16
  v_mfma_f32_16x16x32_bf16 v[76:79], a[84:87], a[20:23], v[76:79]
  s_waitcnt lgkmcnt(8)
  ds_read_b64_tr_b16 a[128:129], v17 offset:16896
  v_mfma_f32_16x16x32_bf16 v[64:67], a[88:91], a[24:27], v[64:67]
  s_sub_u32 s47, 0, s47
  v_mfma_f32_16x16x32_bf16 v[72:75], a[88:91], a[28:31], v[72:75]
  ds_read_b64_tr_b16 a[130:131], v17 offset:17408
  v_mfma_f32_16x16x32_bf16 v[68:71], a[92:95], a[24:27], v[68:71]
  ds_read_b64_tr_b16 a[132:133], v17 offset:16928
  ds_read_b64_tr_b16 a[134:135], v17 offset:17440
  v_mfma_f32_16x16x32_bf16 v[76:79], a[92:95], a[28:31], v[76:79]
  s_waitcnt lgkmcnt(10)
  ds_read_b64_tr_b16 a[136:137], v17 offset:16960
  v_mfma_f32_16x16x32_bf16 v[64:67], a[96:99], a[32:35], v[64:67]
  v_mfma_f32_16x16x32_bf16 v[72:75], a[96:99], a[36:39], v[72:75]
  s_add_u32 m0, s44, 16992
  ds_read_b64_tr_b16 a[138:139], v17 offset:17472
  buffer_load_dwordx4 v19, s[24:27], s42 offen offset:3072 nt lds
  v_mfma_f32_16x16x32_bf16 v[68:71], a[100:103], a[32:35], v[68:71]
  s_add_u32 s42, s42, 16384
  ds_read_b64_tr_b16 a[140:141], v17 offset:16992
  v_mfma_f32_16x16x32_bf16 v[76:79], a[100:103], a[36:39], v[76:79]
  s_waitcnt lgkmcnt(11)
  ds_read_b64_tr_b16 a[142:143], v17 offset:17504
  v_mfma_f32_16x16x32_bf16 v[64:67], a[104:107], a[40:43], v[64:67]
  s_add_u32 s44, s44, s56
  v_mfma_f32_16x16x32_bf16 v[72:75], a[104:107], a[44:47], v[72:75]
  s_sub_u32 s56, 0, s56
  ds_read_b64_tr_b16 a[144:145], v17 offset:17024
  v_mfma_f32_16x16x32_bf16 v[68:71], a[108:111], a[40:43], v[68:71]
  ds_read_b64_tr_b16 a[146:147], v17 offset:17536
  v_mfma_f32_16x16x32_bf16 v[76:79], a[108:111], a[44:47], v[76:79]
  s_waitcnt lgkmcnt(12)
  ds_read_b64_tr_b16 a[148:149], v17 offset:17056
  v_mfma_f32_16x16x32_bf16 v[64:67], a[112:115], a[48:51], v[64:67]
  v_mfma_f32_16x16x32_bf16 v[72:75], a[112:115], a[52:55], v[72:75]
  s_add_u32 m0, s43, 0
  ds_read_b64_tr_b16 a[150:151], v17 offset:17568
  buffer_load_dwordx4 v18, s[20:23], s41 offen offset:0 nt lds
  v_mfma_f32_16x16x32_bf16 v[68:71], a[116:119], a[48:51], v[68:71]
  ds_read_b64_tr_b16 a[152:153], v17 offset:17088
  v_mfma_f32_16x16x32_bf16 v[76:79], a[116:119], a[52:55], v[76:79]
  s_waitcnt lgkmcnt(13)
  ds_read_b64_tr_b16 a[154:155], v17 offset:17600
  v_mfma_f32_16x16x32_bf16 v[64:67], a[120:123], a[56:59], v[64:67]
  v_mfma_f32_16x16x32_bf16 v[72:75], a[120:123], a[60:63], v[72:75]
  ds_read_b64_tr_b16 a[156:157], v17 offset:17120
  v_mfma_f32_16x16x32_bf16 v[68:71], a[124:127], a[56:59], v[68:71]
  ds_read_b64_tr_b16 a[158:159], v17 offset:17632
  ds_read_b64_tr_b16 a[160:161], v17 offset:17152
  v_mfma_f32_16x16x32_bf16 v[76:79], a[124:127], a[60:63], v[76:79]
  s_waitcnt lgkmcnt(13)
  ds_read_b64_tr_b16 a[162:163], v17 offset:17664
  v_mfma_f32_16x16x32_bf16 v[128:131], a[128:131], v[40:43], v[128:131]
  v_mfma_f32_16x16x32_bf16 v[132:135], a[128:131], v[44:47], v[132:135]
  s_add_u32 m0, s43, 32
  ds_read_b64_tr_b16 a[164:165], v17 offset:17184
  buffer_load_dwordx4 v18, s[20:23], s41 offen offset:1024 nt lds
  v_mfma_f32_16x16x32_bf16 v[136:139], a[132:135], v[40:43], v[136:139]
  ds_read_b64_tr_b16 a[166:167], v17 offset:17696
  v_mfma_f32_16x16x32_bf16 v[140:143], a[132:135], v[44:47], v[140:143]
  s_waitcnt lgkmcnt(12)
  ds_read_b64_tr_b16 a[168:169], v17 offset:17216
  v_mfma_f32_16x16x32_bf16 v[144:147], a[136:139], v[40:43], v[144:147]
  v_mfma_f32_16x16x32_bf16 v[148:151], a[136:139], v[44:47], v[148:151]
  ds_read_b64_tr_b16 a[170:171], v17 offset:17728
  v_mfma_f32_16x16x32_bf16 v[152:155], a[140:143], v[40:43], v[152:155]
  s_add_u32 m0, s43, 64
  ds_read_b64_tr_b16 a[172:173], v17 offset:17248
  buffer_load_dwordx4 v18, s[20:23], s41 offen offset:2048 nt lds
  v_mfma_f32_16x16x32_bf16 v[156:159], a[140:143], v[44:47], v[156:159]
  s_waitcnt lgkmcnt(11)
  ds_read_b64_tr_b16 a[174:175], v17 offset:17760
  v_mfma_f32_16x16x32_bf16 v[160:163], a[144:147], v[40:43], v[160:163]
  v_mfma_f32_16x16x32_bf16 v[164:167], a[144:147], v[44:47], v[164:167]
  ds_read_b64_tr_b16 a[176:177], v17 offset:17280
  v_mfma_f32_16x16x32_bf16 v[168:171], a[148:151], v[40:43], v[168:171]
  ds_read_b64_tr_b16 a[178:179], v17 offset:17792
  v_mfma_f32_16x16x32_bf16 v[172:175], a[148:151], v[44:47], v[172:175]
  s_waitcnt lgkmcnt(10)
  v_mfma_f32_16x16x32_bf16 v[176:179], a[152:155], v[40:43], v[176:179]
  ds_read_b64_tr_b16 a[180:181], v17 offset:17312
  v_mfma_f32_16x16x32_bf16 v[180:183], a[152:155], v[44:47], v[180:183]
  s_add_u32 m0, s43, 96
  ds_read_b64_tr_b16 a[182:183], v17 offset:17824
  buffer_load_dwordx4 v18, s[20:23], s41 offen offset:3072 nt lds
  v_mfma_f32_16x16x32_bf16 v[184:187], a[156:159], v[40:43], v[184:187]
  s_add_u32 s41, s41, 16384
  v_mfma_f32_16x16x32_bf16 v[188:191], a[156:159], v[44:47], v[188:191]
  s_waitcnt lgkmcnt(8)
  ds_read_b64_tr_b16 a[184:185], v17 offset:17344
  v_mfma_f32_16x16x32_bf16 v[192:195], a[160:163], v[40:43], v[192:195]
  s_waitcnt vmcnt(12)
  ds_read_b64_tr_b16 a[186:187], v17 offset:17856
  v_mfma_f32_16x16x32_bf16 v[196:199], a[160:163], v[44:47], v[196:199]
  s_barrier
  v_mfma_f32_16x16x32_bf16 v[200:203], a[164:167], v[40:43], v[200:203]
  v_mfma_f32_16x16x32_bf16 v[204:207], a[164:167], v[44:47], v[204:207]
  s_waitcnt lgkmcnt(6)
  ds_read_b64_tr_b16 a[188:189], v17 offset:17376
  v_mfma_f32_16x16x32_bf16 v[208:211], a[168:171], v[40:43], v[208:211]
  ds_read_b64_tr_b16 a[190:191], v17 offset:17888
  v_add_u32 v17, s48, v17
  v_mfma_f32_16x16x32_bf16 v[212:215], a[168:171], v[44:47], v[212:215]
  s_sub_u32 s48, 0, s48
  v_mfma_f32_16x16x32_bf16 v[216:219], a[172:175], v[40:43], v[216:219]
  s_add_u32 m0, s44, 0
  ds_read_b128 a[64:67], v16 offset:0
  buffer_load_dwordx4 v19, s[24:27], s42 offen offset:0 nt lds
  v_mfma_f32_16x16x32_bf16 v[220:223], a[172:175], v[44:47], v[220:223]
  s_waitcnt lgkmcnt(5)
  ds_read_b128 a[68:71], v16 offset:512
  v_mfma_f32_16x16x32_bf16 v[224:227], a[176:179], v[40:43], v[224:227]
  v_mfma_f32_16x16x32_bf16 v[228:231], a[176:179], v[44:47], v[228:231]
  ds_read_b128 a[72:75], v16 offset:64
  v_mfma_f32_16x16x32_bf16 v[232:235], a[180:183], v[40:43], v[232:235]
  ds_read_b128 a[76:79], v16 offset:576
  v_mfma_f32_16x16x32_bf16 v[236:239], a[180:183], v[44:47], v[236:239]
  s_waitcnt lgkmcnt(4)
  ds_read_b128 a[80:83], v16 offset:128
  v_mfma_f32_16x16x32_bf16 v[240:243], a[184:187], v[40:43], v[240:243]
  ds_read_b128 a[84:87], v16 offset:640
  v_add_f32 v22, v22, v8
  v_add_f32 v23, v23, v9
  v_exp_f32 v80, v48
  v_exp_f32 v81, v49
  v_exp_f32 v82, v50
  v_add_f32 v8, v80, v81
  v_cvt_pk_bf16_f32 v32, v80, v81
  v_exp_f32 v83, v51
  v_add_f32 v8, v8, v82
  v_exp_f32 v84, v52
  v_add_f32 v8, v8, v83
  v_cvt_pk_bf16_f32 v33, v82, v83
  v_exp_f32 v85, v53
  v_add_f32 v8, v8, v84
  v_exp_f32 v86, v54
  v_add_f32 v8, v8, v85
  v_cvt_pk_bf16_f32 v34, v84, v85
  v_exp_f32 v87, v55
  v_add_f32 v8, v8, v86
  v_exp_f32 v88, v56
  v_add_f32 v8, v8, v87
  v_cvt_pk_bf16_f32 v35, v86, v87
  v_exp_f32 v89, v57
  v_exp_f32 v90, v58
  v_add_f32 v9, v88, v89
  v_cvt_pk_bf16_f32 v36, v88, v89
  v_exp_f32 v91, v59
  v_add_f32 v9, v9, v90
  v_exp_f32 v92, v60
  v_add_f32 v9, v9, v91
  v_cvt_pk_bf16_f32 v37, v90, v91
  v_exp_f32 v93, v61
  v_add_f32 v9, v9, v92
  v_exp_f32 v94, v62
  v_add_f32 v9, v9, v93
  v_cvt_pk_bf16_f32 v38, v92, v93
  v_exp_f32 v95, v63
  v_add_f32 v9, v9, v94
  v_add_f32 v9, v9, v95
  v_cvt_pk_bf16_f32 v39, v94, v95
  v_max_f32 v20, v8, v9
  v_cmp_lt_f32 vcc, s60, v20
  v_mfma_f32_16x16x32_bf16 v[244:247], a[184:187], v[44:47], v[244:247]
  ds_read_b128 a[88:91], v16 offset:192
  v_mfma_f32_16x16x32_bf16 v[248:251], a[188:191], v[40:43], v[248:251]
  s_waitcnt lgkmcnt(5)
  ds_read_b128 a[92:95], v16 offset:704
  v_mfma_f32_16x16x32_bf16 v[252:255], a[188:191], v[44:47], v[252:255]
  s_cbranch_vccnz L_rare8
L_back8:
L_loop:
  v_mfma_f32_16x16x32_bf16 v[48:51], a[64:67], a[0:3], v[24:27]
  v_exp_f32 v80, v64
  v_mfma_f32_16x16x32_bf16 v[56:59], a[64:67], a[4:7], v[28:31]
  ds_read_b128 a[96:99], v16 offset:256
  v_add_f32 v22, v22, v8
  v_mfma_f32_16x16x32_bf16 v[52:55], a[68:71], a[0:3], v[24:27]
  s_add_u32 m0, s44, 32
  ds_read_b128 a[100:103], v16 offset:768
  buffer_load_dwordx4 v19, s[24:27], s42 offen offset:1024 nt lds
  v_mfma_f32_16x16x32_bf16 v[60:63], a[68:71], a[4:7], v[28:31]
  s_waitcnt lgkmcnt(6)
  ds_read_b128 a[104:107], v16 offset:320
  v_mfma_f32_16x16x32_bf16 v[48:51], a[72:75], a[8:11], v[48:51]
  v_exp_f32 v81, v65
  v_mfma_f32_16x16x32_bf16 v[56:59], a[72:75], a[12:15], v[56:59]
  ds_read_b128 a[108:111], v16 offset:832
  v_add_f32 v8, v80, v81
  v_mfma_f32_16x16x32_bf16 v[52:55], a[76:79], a[8:11], v[52:55]
  ds_read_b128 a[112:115], v16 offset:384
  v_cvt_pk_bf16_f32 v40, v80, v81
  v_mfma_f32_16x16x32_bf16 v[60:63], a[76:79], a[12:15], v[60:63]
  s_waitcnt lgkmcnt(7)
  ds_read_b128 a[116:119], v16 offset:896
  v_mfma_f32_16x16x32_bf16 v[48:51], a[80:83], a[16:19], v[48:51]
  v_exp_f32 v82, v66
  v_mfma_f32_16x16x32_bf16 v[56:59], a[80:83], a[20:23], v[56:59]
  s_add_u32 m0, s44, 64
  ds_read_b128 a[120:123], v16 offset:448
  buffer_load_dwordx4 v19, s[24:27], s42 offen offset:2048 nt lds
  v_mfma_f32_16x16x32_bf16 v[52:55], a[84:87], a[16:19], v[52:55]
  ds_read_b128 a[124:127], v16 offset:960
  v_add_f32 v8, v8, v82
  v_mfma_f32_16x16x32_bf16 v[60:63], a[84:87], a[20:23], v[60:63]
  s_waitcnt lgkmcnt(8)
  ds_read_b64_tr_b16 a[128:129], v17 offset:0
  v_mfma_f32_16x16x32_bf16 v[48:51], a[88:91], a[24:27], v[48:51]
  v_exp_f32 v83, v67
  v_mfma_f32_16x16x32_bf16 v[56:59], a[88:91], a[28:31], v[56:59]
  ds_read_b64_tr_b16 a[130:131], v17 offset:512
  v_add_f32 v8, v8, v83
  v_mfma_f32_16x16x32_bf16 v[52:55], a[92:95], a[24:27], v[52:55]
  ds_read_b64_tr_b16 a[132:133], v17 offset:32
  ds_read_b64_tr_b16 a[134:135], v17 offset:544
  v_mfma_f32_16x16x32_bf16 v[60:63], a[92:95], a[28:31], v[60:63]
  s_waitcnt lgkmcnt(10)
  ds_read_b64_tr_b16 a[136:137], v17 offset:64
  v_cvt_pk_bf16_f32 v41, v82, v83
  v_mfma_f32_16x16x32_bf16 v[48:51], a[96:99], a[32:35], v[48:51]
  v_exp_f32 v84, v68
  v_mfma_f32_16x16x32_bf16 v[56:59], a[96:99], a[36:39], v[56:59]
  s_add_u32 m0, s44, 96
  ds_read_b64_tr_b16 a[138:139], v17 offset:576
  buffer_load_dwordx4 v19, s[24:27], s42 offen offset:3072 nt lds
  v_mfma_f32_16x16x32_bf16 v[52:55], a[100:103], a[32:35], v[52:55]
  s_add_u32 s42, s42, 16384
  ds_read_b64_tr_b16 a[140:141], v17 offset:96
  v_add_f32 v8, v8, v84
  v_mfma_f32_16x16x32_bf16 v[60:63], a[100:103], a[36:39], v[60:63]
  s_waitcnt lgkmcnt(11)
  ds_read_b64_tr_b16 a[142:143], v17 offset:608
  v_mfma_f32_16x16x32_bf16 v[48:51], a[104:107], a[40:43], v[48:51]
  v_exp_f32 v85, v69
  v_mfma_f32_16x16x32_bf16 v[56:59], a[104:107], a[44:47], v[56:59]
  ds_read_b64_tr_b16 a[144:145], v17 offset:128
  v_add_f32 v8, v8, v85
  v_mfma_f32_16x16x32_bf16 v[52:55], a[108:111], a[40:43], v[52:55]
  ds_read_b64_tr_b16 a[146:147], v17 offset:640
  v_cvt_pk_bf16_f32 v42, v84, v85
  v_mfma_f32_16x16x32_bf16 v[60:63], a[108:111], a[44:47], v[60:63]
  s_waitcnt lgkmcnt(12)
  ds_read_b64_tr_b16 a[148:149], v17 offset:160
  v_mfma_f32_16x16x32_bf16 v[48:51], a[112:115], a[48:51], v[48:51]
  v_exp_f32 v86, v70
  v_mfma_f32_16x16x32_bf16 v[56:59], a[112:115], a[52:55], v[56:59]
  s_add_u32 m0, s43, 16896
  ds_read_b64_tr_b16 a[150:151], v17 offset:672
  buffer_load_dwordx4 v18, s[20:23], s41 offen offset:0 nt lds
  v_mfma_f32_16x16x32_bf16 v[52:55], a[116:119], a[48:51], v[52:55]
  ds_read_b64_tr_b16 a[152:153], v17 offset:192
  v_add_f32 v8, v8, v86
  v_mfma_f32_16x16x32_bf16 v[60:63], a[116:119], a[52:55], v[60:63]
  s_waitcnt lgkmcnt(13)
  ds_read_b64_tr_b16 a[154:155], v17 offset:704
  v_mfma_f32_16x16x32_bf16 v[48:51], a[120:123], a[56:59], v[48:51]
  v_exp_f32 v87, v71
  v_mfma_f32_16x16x32_bf16 v[56:59], a[120:123], a[60:63], v[56:59]
  ds_read_b64_tr_b16 a[156:157], v17 offset:224
  v_add_f32 v8, v8, v87
  v_mfma_f32_16x16x32_bf16 v[52:55], a[124:127], a[56:59], v[52:55]
  ds_read_b64_tr_b16 a[158:159], v17 offset:736
  ds_read_b64_tr_b16 a[160:161], v17 offset:256
  v_mfma_f32_16x16x32_bf16 v[60:63], a[124:127], a[60:63], v[60:63]
  s_waitcnt lgkmcnt(13)
  ds_read_b64_tr_b16 a[162:163], v17 offset:768
  v_cvt_pk_bf16_f32 v43, v86, v87
  v_mfma_f32_16x16x32_bf16 v[128:131], a[128:131], v[32:35], v[128:131]
  v_exp_f32 v88, v72
  v_mfma_f32_16x16x32_bf16 v[132:135], a[128:131], v[36:39], v[132:135]
  s_add_u32 m0, s43, 16928
  ds_read_b64_tr_b16 a[164:165], v17 offset:288
  buffer_load_dwordx4 v18, s[20:23], s41 offen offset:1024 nt lds
  v_mfma_f32_16x16x32_bf16 v[136:139], a[132:135], v[32:35], v[136:139]
  ds_read_b64_tr_b16 a[166:167], v17 offset:800
  v_add_f32 v23, v23, v9
  v_mfma_f32_16x16x32_bf16 v[140:143], a[132:135], v[36:39], v[140:143]
  s_waitcnt lgkmcnt(12)
  ds_read_b64_tr_b16 a[168:169], v17 offset:320
  v_mfma_f32_16x16x32_bf16 v[144:147], a[136:139], v[32:35], v[144:147]
  v_exp_f32 v89, v73
  v_mfma_f32_16x16x32_bf16 v[148:151], a[136:139], v[36:39], v[148:151]
  ds_read_b64_tr_b16 a[170:171], v17 offset:832
  v_add_f32 v9, v88, v89
  v_mfma_f32_16x16x32_bf16 v[152:155], a[140:143], v[32:35], v[152:155]
  s_add_u32 m0, s43, 16960
  ds_read_b64_tr_b16 a[172:173], v17 offset:352
  buffer_load_dwordx4 v18, s[20:23], s41 offen offset:2048 nt lds
  v_mfma_f32_16x16x32_bf16 v[156:159], a[140:143], v[36:39], v[156:159]
  s_waitcnt lgkmcnt(11)
  ds_read_b64_tr_b16 a[174:175], v17 offset:864
  v_cvt_pk_bf16_f32 v44, v88, v89
  v_mfma_f32_16x16x32_bf16 v[160:163], a[144:147], v[32:35], v[160:163]
  v_exp_f32 v90, v74
  v_mfma_f32_16x16x32_bf16 v[164:167], a[144:147], v[36:39], v[164:167]
  ds_read_b64_tr_b16 a[176:177], v17 offset:384
  v_add_f32 v9, v9, v90
  v_mfma_f32_16x16x32_bf16 v[168:171], a[148:151], v[32:35], v[168:171]
  ds_read_b64_tr_b16 a[178:179], v17 offset:896
  v_mfma_f32_16x16x32_bf16 v[172:175], a[148:151], v[36:39], v[172:175]
  s_waitcnt lgkmcnt(10)
  v_exp_f32 v91, v75
  v_mfma_f32_16x16x32_bf16 v[176:179], a[152:155], v[32:35], v[176:179]
  ds_read_b64_tr_b16 a[180:181], v17 offset:416
  v_add_f32 v9, v9, v91
  v_mfma_f32_16x16x32_bf16 v[180:183], a[152:155], v[36:39], v[180:183]
  s_add_u32 m0, s43, 16992
  ds_read_b64_tr_b16 a[182:183], v17 offset:928
  buffer_load_dwordx4 v18, s[20:23], s41 offen offset:3072 nt lds
  v_mfma_f32_16x16x32_bf16 v[184:187], a[156:159], v[32:35], v[184:187]
  s_add_u32 s41, s41, 16384
  v_exp_f32 v92, v76
  v_mfma_f32_16x16x32_bf16 v[188:191], a[156:159], v[36:39], v[188:191]
  s_waitcnt lgkmcnt(8)
  ds_read_b64_tr_b16 a[184:185], v17 offset:448
  v_cvt_pk_bf16_f32 v45, v90, v91
  v_mfma_f32_16x16x32_bf16 v[192:195], a[160:163], v[32:35], v[192:195]
  s_waitcnt vmcnt(12)
  ds_read_b64_tr_b16 a[186:187], v17 offset:960
  v_add_f32 v9, v9, v92
  v_mfma_f32_16x16x32_bf16 v[196:199], a[160:163], v[36:39], v[196:199]
  s_barrier
  v_mfma_f32_16x16x32_bf16 v[200:203], a[164:167], v[32:35], v[200:203]
  s_add_u32 s43, s43, s55
  v_exp_f32 v93, v77
  v_mfma_f32_16x16x32_bf16 v[204:207], a[164:167], v[36:39], v[204:207]
  s_waitcnt lgkmcnt(6)
  ds_read_b64_tr_b16 a[188:189], v17 offset:480
  v_add_f32 v9, v9, v93
  v_mfma_f32_16x16x32_bf16 v[208:211], a[168:171], v[32:35], v[208:211]
  s_sub_u32 s55, 0, s55
  ds_read_b64_tr_b16 a[190:191], v17 offset:992
  v_cvt_pk_bf16_f32 v46, v92, v93
  v_mfma_f32_16x16x32_bf16 v[212:215], a[168:171], v[36:39], v[212:215]
  v_exp_f32 v94, v78
  v_mfma_f32_16x16x32_bf16 v[216:219], a[172:175], v[32:35], v[216:219]
  s_add_u32 m0, s44, 16896
  ds_read_b128 a[64:67], v16 offset:16896
  buffer_load_dwordx4 v19, s[24:27], s42 offen offset:0 nt lds
  v_mfma_f32_16x16x32_bf16 v[220:223], a[172:175], v[36:39], v[220:223]
  s_waitcnt lgkmcnt(5)
  ds_read_b128 a[68:71], v16 offset:17408
  v_add_f32 v9, v9, v94
  v_mfma_f32_16x16x32_bf16 v[224:227], a[176:179], v[32:35], v[224:227]
  v_exp_f32 v95, v79
  v_mfma_f32_16x16x32_bf16 v[228:231], a[176:179], v[36:39], v[228:231]
  ds_read_b128 a[72:75], v16 offset:16960
  v_add_f32 v9, v9, v95
  v_mfma_f32_16x16x32_bf16 v[232:235], a[180:183], v[32:35], v[232:235]
  ds_read_b128 a[76:79], v16 offset:17472
  v_cvt_pk_bf16_f32 v47, v94, v95
  v_mfma_f32_16x16x32_bf16 v[236:239], a[180:183], v[36:39], v[236:239]
  s_waitcnt lgkmcnt(4)
  ds_read_b128 a[80:83], v16 offset:17024
  v_max_f32 v20, v8, v9
  v_mfma_f32_16x16x32_bf16 v[240:243], a[184:187], v[32:35], v[240:243]
  ds_read_b128 a[84:87], v16 offset:17536
  v_cmp_lt_f32 vcc, s60, v20
  v_mfma_f32_16x16x32_bf16 v[244:247], a[184:187], v[36:39], v[244:247]
  ds_read_b128 a[88:91], v16 offset:17088
  v_mfma_f32_16x16x32_bf16 v[248:251], a[188:191], v[32:35], v[248:251]
  s_waitcnt lgkmcnt(5)
  ds_read_b128 a[92:95], v16 offset:17600
  v_mfma_f32_16x16x32_bf16 v[252:255], a[188:191], v[36:39], v[252:255]
  s_cbranch_vccnz L_rare0
L_back0:
  v_mfma_f32_16x16x32_bf16 v[64:67], a[64:67], a[0:3], v[24:27]
  v_exp_f32 v80, v48
  v_mfma_f32_16x16x32_bf16 v[72:75], a[64:67], a[4:7], v[28:31]
  ds_read_b128 a[96:99], v16 offset:17152
  v_add_f32 v22, v22, v8
  v_mfma_f32_16x16x32_bf16 v[68:71], a[68:71], a[0:3], v[24:27]
  s_add_u32 m0, s44, 16928
  ds_read_b128 a[100:103], v16 offset:17664
  buffer_load_dwordx4 v19, s[24:27], s42 offen offset:1024 nt lds
  v_mfma_f32_16x16x32_bf16 v[76:79], a[68:71], a[4:7], v[28:31]
  s_waitcnt lgkmcnt(6)
  ds_read_b128 a[104:107], v16 offset:17216
  v_mfma_f32_16x16x32_bf16 v[64:67], a[72:75], a[8:11], v[64:67]
  v_exp_f32 v81, v49
  v_mfma_f32_16x16x32_bf16 v[72:75], a[72:75], a[12:15], v[72:75]
  ds_read_b128 a[108:111], v16 offset:17728
  v_add_f32 v8, v80, v81
  v_mfma_f32_16x16x32_bf16 v[68:71], a[76:79], a[8:11], v[68:71]
  ds_read_b128 a[112:115], v16 offset:17280
  v_cvt_pk_bf16_f32 v32, v80, v81
  v_mfma_f32_16x16x32_bf16 v[76:79], a[76:79], a[12:15], v[76:79]
  s_waitcnt lgkmcnt(7)
  ds_read_b128 a[116:119], v16 offset:17792
  v_mfma_f32_16x16x32_bf16 v[64:67], a[80:83], a[16:19], v[64:67]
  v_exp_f32 v82, v50
  v_mfma_f32_16x16x32_bf16 v[72:75], a[80:83], a[20:23], v[72:75]
  s_add_u32 m0, s44, 16960
  ds_read_b128 a[120:123], v16 offset:17344
  buffer_load_dwordx4 v19, s[24:27], s42 offen offset:2048 nt lds
  v_mfma_f32_16x16x32_bf16 v[68:71], a[84:87], a[16:19], v[68:71]
  ds_read_b128 a[124:127], v16 offset:17856
  v_add_u32 v16, s47, v16
  v_mfma_f32_16x16x32_bf16 v[76:79], a[84:87], a[20:23], v[76:79]
  s_waitcnt lgkmcnt(8)
  ds_read_b64_tr_b16 a[128:129], v17 offset:16896
  v_add_f32 v8, v8, v82
  v_mfma_f32_16x16x32_bf16 v[64:67], a[88:91], a[24:27], v[64:67]
  s_sub_u32 s47, 0, s47
  v_exp_f32 v83, v51
  v_mfma_f32_16x16x32_bf16 v[72:75], a[88:91], a[28:31], v[72:75]
  ds_read_b64_tr_b16 a[130:131], v17 offset:17408
  v_add_f32 v8, v8, v83
  v_mfma_f32_16x16x32_bf16 v[68:71], a[92:95], a[24:27], v[68:71]
  ds_read_b64_tr_b16 a[132:133], v17 offset:16928
  ds_read_b64_tr_b16 a[134:135], v17 offset:17440
  v_mfma_f32_16x16x32_bf16 v[76:79], a[92:95], a[28:31], v[76:79]
  s_waitcnt lgkmcnt(10)
  ds_read_b64_tr_b16 a[136:137], v17 offset:16960
  v_cvt_pk_bf16_f32 v33, v82, v83
  v_mfma_f32_16x16x32_bf16 v[64:67], a[96:99], a[32:35], v[64:67]
  v_exp_f32 v84, v52
  v_mfma_f32_16x16x32_bf16 v[72:75], a[96:99], a[36:39], v[72:75]
  s_add_u32 m0, s44, 16992
  ds_read_b64_tr_b16 a[138:139], v17 offset:17472
  buffer_load_dwordx4 v19, s[24:27], s42 offen offset:3072 nt lds
  v_mfma_f32_16x16x32_bf16 v[68:71], a[100:103], a[32:35], v[68:71]
  s_add_u32 s42, s42, 16384
  ds_read_b64_tr_b16 a[140:141], v17 offset:16992
  v_add_f32 v8, v8, v84
  v_mfma_f32_16x16x32_bf16 v[76:79], a[100:103], a[36:39], v[76:79]
  s_waitcnt lgkmcnt(11)
  ds_read_b64_tr_b16 a[142:143], v17 offset:17504
  v_mfma_f32_16x16x32_bf16 v[64:67], a[104:107], a[40:43], v[64:67]
  s_add_u32 s44, s44, s56
  v_exp_f32 v85, v53
  v_mfma_f32_16x16x32_bf16 v[72:75], a[104:107], a[44:47], v[72:75]
  s_sub_u32 s56, 0, s56
  ds_read_b64_tr_b16 a[144:145], v17 offset:17024
  v_add_f32 v8, v8, v85
  v_mfma_f32_16x16x32_bf16 v[68:71], a[108:111], a[40:43], v[68:71]
  ds_read_b64_tr_b16 a[146:147], v17 offset:17536
  v_cvt_pk_bf16_f32 v34, v84, v85
  v_mfma_f32_16x16x32_bf16 v[76:79], a[108:111], a[44:47], v[76:79]
  s_waitcnt lgkmcnt(12)
  ds_read_b64_tr_b16 a[148:149], v17 offset:17056
  v_mfma_f32_16x16x32_bf16 v[64:67], a[112:115], a[48:51], v[64:67]
  v_exp_f32 v86, v54
  v_mfma_f32_16x16x32_bf16 v[72:75], a[112:115], a[52:55], v[72:75]
  s_add_u32 m0, s43, 0
  ds_read_b64_tr_b16 a[150:151], v17 offset:17568
  buffer_load_dwordx4 v18, s[20:23], s41 offen offset:0 nt lds
  v_mfma_f32_16x16x32_bf16 v[68:71], a[116:119], a[48:51], v[68:71]
  ds_read_b64_tr_b16 a[152:153], v17 offset:17088
  v_add_f32 v8, v8, v86
  v_mfma_f32_16x16x32_bf16 v[76:79], a[116:119], a[52:55], v[76:79]
  s_waitcnt lgkmcnt(13)
  ds_read_b64_tr_b16 a[154:155], v17 offset:17600
  v_mfma_f32_16x16x32_bf16 v[64:67], a[120:123], a[56:59], v[64:67]
  v_exp_f32 v87, v55
  v_mfma_f32_16x16x32_bf16 v[72:75], a[120:123], a[60:63], v[72:75]
  ds_read_b64_tr_b16 a[156:157], v17 offset:17120
  v_add_f32 v8, v8, v87
  v_mfma_f32_16x16x32_bf16 v[68:71], a[124:127], a[56:59], v[68:71]
  ds_read_b64_tr_b16 a[158:159], v17 offset:17632
  ds_read_b64_tr_b16 a[160:161], v17 offset:17152
  v_mfma_f32_16x16x32_bf16 v[76:79], a[124:127], a[60:63], v[76:79]
  s_waitcnt lgkmcnt(13)
  ds_read_b64_tr_b16 a[162:163], v17 offset:17664
  v_cvt_pk_bf16_f32 v35, v86, v87
  v_mfma_f32_16x16x32_bf16 v[128:131], a[128:131], v[40:43], v[128:131]
  v_exp_f32 v88, v56
  v_mfma_f32_16x16x32_bf16 v[132:135], a[128:131], v[44:47], v[132:135]
  s_add_u32 m0, s43, 32
  ds_read_b64_tr_b16 a[164:165], v17 offset:17184
  buffer_load_dwordx4 v18, s[20:23], s41 offen offset:1024 nt lds
  v_mfma_f32_16x16x32_bf16 v[136:139], a[132:135], v[40:43], v[136:139]
  ds_read_b64_tr_b16 a[166:167], v17 offset:17696
  v_add_f32 v23, v23, v9
  v_mfma_f32_16x16x32_bf16 v[140:143], a[132:135], v[44:47], v[140:143]
  s_waitcnt lgkmcnt(12)
  ds_read_b64_tr_b16 a[168:169], v17 offset:17216
  v_mfma_f32_16x16x32_bf16 v[144:147], a[136:139], v[40:43], v[144:147]
  v_exp_f32 v89, v57
  v_mfma_f32_16x16x32_bf16 v[148:151], a[136:139], v[44:47], v[148:151]
  ds_read_b64_tr_b16 a[170:171], v17 offset:17728
  v_add_f32 v9, v88, v89
  v_mfma_f32_16x16x32_bf16 v[152:155], a[140:143], v[40:43], v[152:155]
  s_add_u32 m0, s43, 64
  ds_read_b64_tr_b16 a[172:173], v17 offset:17248
  buffer_load_dwordx4 v18, s[20:23], s41 offen offset:2048 nt lds
  v_mfma_f32_16x16x32_bf16 v[156:159], a[140:143], v[44:47], v[156:159]
  s_waitcnt lgkmcnt(11)
  ds_read_b64_tr_b16 a[174:175], v17 offset:17760
  v_cvt_pk_bf16_f32 v36, v88, v89
  v_mfma_f32_16x16x32_bf16 v[160:163], a[144:147], v[40:43], v[160:163]
  v_exp_f32 v90, v58
  v_mfma_f32_16x16x32_bf16 v[164:167], a[144:147], v[44:47], v[164:167]
  ds_read_b64_tr_b16 a[176:177], v17 offset:17280
  v_add_f32 v9, v9, v90
  v_mfma_f32_16x16x32_bf16 v[168:171], a[148:151], v[40:43], v[168:171]
  ds_read_b64_tr_b16 a[178:179], v17 offset:17792
  v_mfma_f32_16x16x32_bf16 v[172:175], a[148:151], v[44:47], v[172:175]
  s_waitcnt lgkmcnt(10)
  v_exp_f32 v91, v59
  v_mfma_f32_16x16x32_bf16 v[176:179], a[152:155], v[40:43], v[176:179]
  ds_read_b64_tr_b16 a[180:181], v17 offset:17312
  v_add_f32 v9, v9, v91
  v_mfma_f32_16x16x32_bf16 v[180:183], a[152:155], v[44:47], v[180:183]
  s_add_u32 m0, s43, 96
  ds_read_b64_tr_b16 a[182:183], v17 offset:17824
  buffer_load_dwordx4 v18, s[20:23], s41 offen offset:3072 nt lds
  v_mfma_f32_16x16x32_bf16 v[184:187], a[156:159], v[40:43], v[184:187]
  s_add_u32 s41, s41, 16384
  v_exp_f32 v92, v60
  v_mfma_f32_16x16x32_bf16 v[188:191], a[156:159], v[44:47], v[188:191]
  s_waitcnt lgkmcnt(8)
  ds_read_b64_tr_b16 a[184:185], v17 offset:17344
  v_cvt_pk_bf16_f32 v37, v90, v91
  v_mfma_f32_16x16x32_bf16 v[192:195], a[160:163], v[40:43], v[192:195]
  s_waitcnt vmcnt(12)
  ds_read_b64_tr_b16 a[186:187], v17 offset:17856
  v_add_f32 v9, v9, v92
  v_mfma_f32_16x16x32_bf16 v[196:199], a[160:163], v[44:47], v[196:199]
  s_barrier
  v_mfma_f32_16x16x32_bf16 v[200:203], a[164:167], v[40:43], v[200:203]
  v_exp_f32 v93, v61
  v_mfma_f32_16x16x32_bf16 v[204:207], a[164:167], v[44:47], v[204:207]
  s_waitcnt lgkmcnt(6)
  ds_read_b64_tr_b16 a[188:189], v17 offset:17376
  v_add_f32 v9, v9, v93
  v_mfma_f32_16x16x32_bf16 v[208:211], a[168:171], v[40:43], v[208:211]
  ds_read_b64_tr_b16 a[190:191], v17 offset:17888
  v_add_u32 v17, s48, v17
  v_mfma_f32_16x16x32_bf16 v[212:215], a[168:171], v[44:47], v[212:215]
  s_sub_u32 s48, 0, s48
  v_exp_f32 v94, v62
  v_mfma_f32_16x16x32_bf16 v[216:219], a[172:175], v[40:43], v[216:219]
  s_add_u32 m0, s44, 0
  ds_read_b128 a[64:67], v16 offset:0
  buffer_load_dwordx4 v19, s[24:27], s42 offen offset:0 nt lds
  v_mfma_f32_16x16x32_bf16 v[220:223], a[172:175], v[44:47], v[220:223]
  s_waitcnt lgkmcnt(5)
  ds_read_b128 a[68:71], v16 offset:512
  v_cvt_pk_bf16_f32 v38, v92, v93
  v_mfma_f32_16x16x32_bf16 v[224:227], a[176:179], v[40:43], v[224:227]
  s_sub_u32 s45, s45, 1
  v_exp_f32 v95, v63
  v_mfma_f32_16x16x32_bf16 v[228:231], a[176:179], v[44:47], v[228:231]
  s_cselect_b32 s61, -1.0, s60
  ds_read_b128 a[72:75], v16 offset:64
  v_add_f32 v9, v9, v94
  v_mfma_f32_16x16x32_bf16 v[232:235], a[180:183], v[40:43], v[232:235]
  ds_read_b128 a[76:79], v16 offset:576
  v_add_f32 v9, v9, v95
  v_mfma_f32_16x16x32_bf16 v[236:239], a[180:183], v[44:47], v[236:239]
  s_waitcnt lgkmcnt(4)
  ds_read_b128 a[80:83], v16 offset:128
  v_cvt_pk_bf16_f32 v39, v94, v95
  v_mfma_f32_16x16x32_bf16 v[240:243], a[184:187], v[40:43], v[240:243]
  ds_read_b128 a[84:87], v16 offset:640
  v_max_f32 v20, v8, v9
  v_mfma_f32_16x16x32_bf16 v[244:247], a[184:187], v[44:47], v[244:247]
  ds_read_b128 a[88:91], v16 offset:192
  v_cmp_lt_f32 vcc, s61, v20
  v_mfma_f32_16x16x32_bf16 v[248:251], a[188:191], v[40:43], v[248:251]
  s_waitcnt lgkmcnt(5)
  ds_read_b128 a[92:95], v16 offset:704
  v_mfma_f32_16x16x32_bf16 v[252:255], a[188:191], v[44:47], v[252:255]
  s_cbranch_vccz L_loop
  v_cmp_lt_f32 vcc, s60, v20
  s_cmp_lt_i32 s45, 0
  s_nop 0
  s_cbranch_vccnz L_rare1
L_back1:
  s_cbranch_scc0 L_loop
L_tail:
  v_mfma_f32_16x16x32_bf16 v[48:51], a[64:67], a[0:3], v[24:27]
  s_add_u32 m0, s44, 32
  ds_read_b128 a[96:99], v16 offset:256
  v_mfma_f32_16x16x32_bf16 v[56:59], a[64:67], a[4:7], v[28:31]
  buffer_load_dwordx4 v19, s[24:27], s42 offen offset:1024 nt lds
  ds_read_b128 a[100:103], v16 offset:768
  v_mfma_f32_16x16x32_bf16 v[52:55], a[68:71], a[0:3], v[24:27]
  s_add_u32 m0, s44, 64
  v_exp_f32 v80, v64
  v_mfma_f32_16x16x32_bf16 v[60:63], a[68:71], a[4:7], v[28:31]
  s_waitcnt lgkmcnt(6)
  buffer_load_dwordx4 v19, s[24:27], s42 offen offset:2048 nt lds
  v_add_f32 v22, v22, v8
  v_mfma_f32_16x16x32_bf16 v[48:51], a[72:75], a[8:11], v[48:51]
  s_add_u32 m0, s44, 96
  v_exp_f32 v81, v65
  v_mfma_f32_16x16x32_bf16 v[56:59], a[72:75], a[12:15], v[56:59]
  buffer_load_dwordx4 v19, s[24:27], s42 offen offset:3072 nt lds
  ds_read_b128 a[104:107], v16 offset:320
  v_mfma_f32_16x16x32_bf16 v[52:55], a[76:79], a[8:11], v[52:55]
  s_add_u32 s42, s42, 16384
  ds_read_b128 a[108:111], v16 offset:832
  v_add_f32 v8, v80, v81
  v_mfma_f32_16x16x32_bf16 v[60:63], a[76:79], a[12:15], v[60:63]
  s_waitcnt lgkmcnt(6)
  s_add_u32 m0, s44, 33792
  v_cvt_pk_bf16_f32 v40, v80, v81
  v_mfma_f32_16x16x32_bf16 v[48:51], a[80:83], a[16:19], v[48:51]
  buffer_load_dwordx4 v19, s[24:27], s42 offen offset:0 nt lds
  ds_read_b128 a[112:115], v16 offset:384
  v_exp_f32 v82, v66
  v_mfma_f32_16x16x32_bf16 v[56:59], a[80:83], a[20:23], v[56:59]
  s_add_u32 m0, s44, 33824
  ds_read_b128 a[116:119], v16 offset:896
  v_add_f32 v8, v8, v82
  v_mfma_f32_16x16x32_bf16 v[52:55], a[84:87], a[16:19], v[52:55]
  buffer_load_dwordx4 v19, s[24:27], s42 offen offset:1024 nt lds
  ds_read_b128 a[120:123], v16 offset:448
  v_exp_f32 v83, v67
  v_mfma_f32_16x16x32_bf16 v[60:63], a[84:87], a[20:23], v[60:63]
  s_waitcnt lgkmcnt(7)
  s_add_u32 m0, s44, 33856
  v_add_f32 v8, v8, v83
  v_mfma_f32_16x16x32_bf16 v[48:51], a[88:91], a[24:27], v[48:51]
  buffer_load_dwordx4 v19, s[24:27], s42 offen offset:2048 nt lds
  ds_read_b128 a[124:127], v16 offset:960
  v_cvt_pk_bf16_f32 v41, v82, v83
  v_mfma_f32_16x16x32_bf16 v[56:59], a[88:91], a[28:31], v[56:59]
  s_add_u32 m0, s44, 33888
  ds_read_b64_tr_b16 a[160:161], v17 offset:256
  v_exp_f32 v84, v68
  v_mfma_f32_16x16x32_bf16 v[52:55], a[92:95], a[24:27], v[52:55]
  buffer_load_dwordx4 v19, s[24:27], s42 offen offset:3072 nt lds
  v_add_f32 v8, v8, v84
  v_mfma_f32_16x16x32_bf16 v[60:63], a[92:95], a[28:31], v[60:63]
  s_waitcnt lgkmcnt(7)
  ds_read_b64_tr_b16 a[162:163], v17 offset:768
  v_exp_f32 v85, v69
  v_mfma_f32_16x16x32_bf16 v[48:51], a[96:99], a[32:35], v[48:51]
  ds_read_b64_tr_b16 a[164:165], v17 offset:288
  v_add_f32 v8, v8, v85
  v_mfma_f32_16x16x32_bf16 v[56:59], a[96:99], a[36:39], v[56:59]
  ds_read_b64_tr_b16 a[166:167], v17 offset:800
  v_cvt_pk_bf16_f32 v42, v84, v85
  v_mfma_f32_16x16x32_bf16 v[52:55], a[100:103], a[32:35], v[52:55]
  v_exp_f32 v86, v70
  v_mfma_f32_16x16x32_bf16 v[60:63], a[100:103], a[36:39], v[60:63]
  s_waitcnt lgkmcnt(8)
  ds_read_b64_tr_b16 a[168:169], v17 offset:320
  v_add_f32 v8, v8, v86
  v_mfma_f32_16x16x32_bf16 v[48:51], a[104:107], a[40:43], v[48:51]
  ds_read_b64_tr_b16 a[170:171], v17 offset:832
  ds_read_b64_tr_b16 a[172:173], v17 offset:352
  v_mfma_f32_16x16x32_bf16 v[56:59], a[104:107], a[44:47], v[56:59]
  v_exp_f32 v87, v71
  v_mfma_f32_16x16x32_bf16 v[52:55], a[108:111], a[40:43], v[52:55]
  v_add_f32 v8, v8, v87
  v_cvt_pk_bf16_f32 v43, v86, v87
  v_mfma_f32_16x16x32_bf16 v[60:63], a[108:111], a[44:47], v[60:63]
  s_waitcnt lgkmcnt(9)
  ds_read_b64_tr_b16 a[174:175], v17 offset:864
  ds_read_b64_tr_b16 a[176:177], v17 offset:384
  v_mfma_f32_16x16x32_bf16 v[48:51], a[112:115], a[48:51], v[48:51]
  v_exp_f32 v88, v72
  v_mfma_f32_16x16x32_bf16 v[56:59], a[112:115], a[52:55], v[56:59]
  ds_read_b64_tr_b16 a[178:179], v17 offset:896
  v_add_f32 v23, v23, v9
  v_mfma_f32_16x16x32_bf16 v[52:55], a[116:119], a[48:51], v[52:55]
  v_exp_f32 v89, v73
  v_mfma_f32_16x16x32_bf16 v[60:63], a[116:119], a[52:55], v[60:63]
  s_waitcnt lgkmcnt(10)
  ds_read_b64_tr_b16 a[180:181], v17 offset:416
  v_add_f32 v9, v88, v89
  v_mfma_f32_16x16x32_bf16 v[48:51], a[120:123], a[56:59], v[48:51]
  ds_read_b64_tr_b16 a[182:183], v17 offset:928
  v_cvt_pk_bf16_f32 v44, v88, v89
  v_mfma_f32_16x16x32_bf16 v[56:59], a[120:123], a[60:63], v[56:59]
  v_exp_f32 v90, v74
  v_mfma_f32_16x16x32_bf16 v[52:55], a[124:127], a[56:59], v[52:55]
  ds_read_b64_tr_b16 a[184:185], v17 offset:448
  v_add_f32 v9, v9, v90
  v_mfma_f32_16x16x32_bf16 v[60:63], a[124:127], a[60:63], v[60:63]
  s_waitcnt lgkmcnt(9)
  ds_read_b64_tr_b16 a[186:187], v17 offset:960
  v_exp_f32 v91, v75
  v_mfma_f32_16x16x32_bf16 v[192:195], a[160:163], v[32:35], v[192:195]
  ds_read_b64_tr_b16 a[188:189], v17 offset:480
  v_add_f32 v9, v9, v91
  v_mfma_f32_16x16x32_bf16 v[196:199], a[160:163], v[36:39], v[196:199]
  s_waitcnt vmcnt(12)
  s_barrier
  v_cvt_pk_bf16_f32 v45, v90, v91
  v_mfma_f32_16x16x32_bf16 v[200:203], a[164:167], v[32:35], v[200:203]
  ds_read_b64_tr_b16 a[190:191], v17 offset:992
  ds_read_b128 a[64:67], v16 offset:16896
  v_mfma_f32_16x16x32_bf16 v[204:207], a[164:167], v[36:39], v[204:207]
  s_waitcnt lgkmcnt(9)
  v_exp_f32 v92, v76
  v_mfma_f32_16x16x32_bf16 v[208:211], a[168:171], v[32:35], v[208:211]
  ds_read_b128 a[68:71], v16 offset:17408
  v_add_f32 v9, v9, v92
  v_mfma_f32_16x16x32_bf16 v[212:215], a[168:171], v[36:39], v[212:215]
  v_exp_f32 v93, v77
  v_mfma_f32_16x16x32_bf16 v[216:219], a[172:175], v[32:35], v[216:219]
  v_add_f32 v9, v9, v93
  v_cvt_pk_bf16_f32 v46, v92, v93
  v_mfma_f32_16x16x32_bf16 v[220:223], a[172:175], v[36:39], v[220:223]
  s_waitcnt lgkmcnt(6)
  ds_read_b128 a[72:75], v16 offset:16960
  ds_read_b128 a[76:79], v16 offset:17472
  v_mfma_f32_16x16x32_bf16 v[224:227], a[176:179], v[32:35], v[224:227]
  v_exp_f32 v94, v78
  v_mfma_f32_16x16x32_bf16 v[228:231], a[176:179], v[36:39], v[228:231]
  ds_read_b128 a[80:83], v16 offset:17024
  v_add_f32 v9, v9, v94
  v_mfma_f32_16x16x32_bf16 v[232:235], a[180:183], v[32:35], v[232:235]
  v_exp_f32 v95, v79
  v_mfma_f32_16x16x32_bf16 v[236:239], a[180:183], v[36:39], v[236:239]
  s_waitcnt lgkmcnt(5)
  ds_read_b128 a[84:87], v16 offset:17536
  v_add_f32 v9, v9, v95
  v_mfma_f32_16x16x32_bf16 v[240:243], a[184:187], v[32:35], v[240:243]
  v_cvt_pk_bf16_f32 v47, v94, v95
  v_max_f32 v20, v8, v9
  v_mfma_f32_16x16x32_bf16 v[244:247], a[184:187], v[36:39], v[244:247]
  ds_read_b128 a[88:91], v16 offset:17088
  v_cmp_lt_f32 vcc, s60, v20
  v_mfma_f32_16x16x32_bf16 v[248:251], a[188:191], v[32:35], v[248:251]
  s_waitcnt lgkmcnt(5)
  ds_read_b128 a[92:95], v16 offset:17600
  v_mfma_f32_16x16x32_bf16 v[252:255], a[188:191], v[36:39], v[252:255]
  s_cbranch_vccnz L_rare3
L_back3:
  v_mfma_f32_16x16x32_bf16 v[64:67], a[64:67], a[0:3], v[24:27]
  ds_read_b128 a[96:99], v16 offset:17152
  v_mfma_f32_16x16x32_bf16 v[72:75], a[64:67], a[4:7], v[28:31]
  buffer_load_dwordx4 a[192:195], v12, s[28:31], s51 offen offset:0
  ds_read_b128 a[100:103], v16 offset:17664
  v_mfma_f32_16x16x32_bf16 v[68:71], a[68:71], a[0:3], v[24:27]
  v_exp_f32 v80, v48
  v_mfma_f32_16x16x32_bf16 v[76:79], a[68:71], a[4:7], v[28:31]
  s_waitcnt lgkmcnt(6)
  ds_read_b128 a[104:107], v16 offset:17216
  v_add_f32 v22, v22, v8
  v_mfma_f32_16x16x32_bf16 v[64:67], a[72:75], a[8:11], v[64:67]
  buffer_load_dwordx4 a[192:195], v12, s[28:31], s51 offen offset:512
  s_add_u32 s51, s51, 4096
  v_exp_f32 v81, v49
  v_mfma_f32_16x16x32_bf16 v[72:75], a[72:75], a[12:15], v[72:75]
  ds_read_b128 a[108:111], v16 offset:17728
  v_add_f32 v8, v80, v81
  v_mfma_f32_16x16x32_bf16 v[68:71], a[76:79], a[8:11], v[68:71]
  ds_read_b128 a[112:115], v16 offset:17280
  v_cvt_pk_bf16_f32 v112, v80, v81
  v_mfma_f32_16x16x32_bf16 v[76:79], a[76:79], a[12:15], v[76:79]
  s_waitcnt lgkmcnt(7)
  buffer_load_dwordx4 a[192:195], v12, s[28:31], s51 offen offset:0
  ds_read_b128 a[116:119], v16 offset:17792
  v_mfma_f32_16x16x32_bf16 v[64:67], a[80:83], a[16:19], v[64:67]
  v_exp_f32 v82, v50
  v_mfma_f32_16x16x32_bf16 v[72:75], a[80:83], a[20:23], v[72:75]
  ds_read_b128 a[120:123], v16 offset:17344
  v_add_f32 v8, v8, v82
  v_mfma_f32_16x16x32_bf16 v[68:71], a[84:87], a[16:19], v[68:71]
  buffer_load_dwordx4 a[192:195], v12, s[28:31], s51 offen offset:512
  s_add_u32 s51, s51, 4096
  v_exp_f32 v83, v51
  v_mfma_f32_16x16x32_bf16 v[76:79], a[84:87], a[20:23], v[76:79]
  s_waitcnt lgkmcnt(7)
  ds_read_b128 a[124:127], v16 offset:17856
  v_add_f32 v8, v8, v83
  v_mfma_f32_16x16x32_bf16 v[64:67], a[88:91], a[24:27], v[64:67]
  ds_read_b64_tr_b16 a[160:161], v17 offset:17152
  v_cvt_pk_bf16_f32 v113, v82, v83
  v_mfma_f32_16x16x32_bf16 v[72:75], a[88:91], a[28:31], v[72:75]
  buffer_load_dwordx4 a[192:195], v12, s[28:31], s51 offen offset:0
  v_exp_f32 v84, v52
  v_mfma_f32_16x16x32_bf16 v[68:71], a[92:95], a[24:27], v[68:71]
  ds_read_b64_tr_b16 a[162:163], v17 offset:17664
  v_add_f32 v8, v8, v84
  v_mfma_f32_16x16x32_bf16 v[76:79], a[92:95], a[28:31], v[76:79]
  s_waitcnt lgkmcnt(8)
  v_exp_f32 v85, v53
  v_mfma_f32_16x16x32_bf16 v[64:67], a[96:99], a[32:35], v[64:67]
  buffer_load_dwordx4 a[192:195], v12, s[28:31], s51 offen offset:512
  ds_read_b64_tr_b16 a[164:165], v17 offset:17184
  s_add_u32 s51, s51, 4096
  v_mfma_f32_16x16x32_bf16 v[72:75], a[96:99], a[36:39], v[72:75]
  ds_read_b64_tr_b16 a[166:167], v17 offset:17696
  v_add_f32 v8, v8, v85
  v_mfma_f32_16x16x32_bf16 v[68:71], a[100:103], a[32:35], v[68:71]
  v_cvt_pk_bf16_f32 v114, v84, v85
  v_exp_f32 v86, v54
  v_mfma_f32_16x16x32_bf16 v[76:79], a[100:103], a[36:39], v[76:79]
  s_waitcnt lgkmcnt(8)
  buffer_load_dwordx4 a[192:195], v12, s[28:31], s51 offen offset:0
  ds_read_b64_tr_b16 a[168:169], v17 offset:17216
  v_mfma_f32_16x16x32_bf16 v[64:67], a[104:107], a[40:43], v[64:67]
  ds_read_b64_tr_b16 a[170:171], v17 offset:17728
  v_add_f32 v8, v8, v86
  v_mfma_f32_16x16x32_bf16 v[72:75], a[104:107], a[44:47], v[72:75]
  v_exp_f32 v87, v55
  v_mfma_f32_16x16x32_bf16 v[68:71], a[108:111], a[40:43], v[68:71]
  buffer_load_dwordx4 a[192:195], v12, s[28:31], s51 offen offset:512
  ds_read_b64_tr_b16 a[172:173], v17 offset:17248
  v_add_f32 v8, v8, v87
  v_mfma_f32_16x16x32_bf16 v[76:79], a[108:111], a[44:47], v[76:79]
  s_waitcnt lgkmcnt(9)
  ds_read_b64_tr_b16 a[174:175], v17 offset:17760
  v_cvt_pk_bf16_f32 v115, v86, v87
  v_mfma_f32_16x16x32_bf16 v[64:67], a[112:115], a[48:51], v[64:67]
  ds_read_b64_tr_b16 a[176:177], v17 offset:17280
  v_exp_f32 v88, v56
  v_mfma_f32_16x16x32_bf16 v[72:75], a[112:115], a[52:55], v[72:75]
  buffer_load_dwordx4 a[192:195], v15, s[32:35], s58 offen offset:256
  v_add_f32 v23, v23, v9
  v_mfma_f32_16x16x32_bf16 v[68:71], a[116:119], a[48:51], v[68:71]
  ds_read_b64_tr_b16 a[178:179], v17 offset:17792
  v_exp_f32 v89, v57
  v_mfma_f32_16x16x32_bf16 v[76:79], a[116:119], a[52:55], v[76:79]
  s_waitcnt lgkmcnt(10)
  ds_read_b64_tr_b16 a[180:181], v17 offset:17312
  v_add_f32 v9, v88, v89
  v_mfma_f32_16x16x32_bf16 v[64:67], a[120:123], a[56:59], v[64:67]
  ds_read_b64_tr_b16 a[182:183], v17 offset:17824
  v_cvt_pk_bf16_f32 v116, v88, v89
  v_mfma_f32_16x16x32_bf16 v[72:75], a[120:123], a[60:63], v[72:75]
  v_exp_f32 v90, v58
  v_mfma_f32_16x16x32_bf16 v[68:71], a[124:127], a[56:59], v[68:71]
  ds_read_b64_tr_b16 a[184:185], v17 offset:17344
  v_add_f32 v9, v9, v90
  v_mfma_f32_16x16x32_bf16 v[76:79], a[124:127], a[60:63], v[76:79]
  s_waitcnt lgkmcnt(9)
  ds_read_b64_tr_b16 a[186:187], v17 offset:17856
  v_exp_f32 v91, v59
  v_mfma_f32_16x16x32_bf16 v[192:195], a[160:163], v[40:43], v[192:195]
  ds_read_b64_tr_b16 a[188:189], v17 offset:17376
  v_add_f32 v9, v9, v91
  v_mfma_f32_16x16x32_bf16 v[196:199], a[160:163], v[44:47], v[196:199]
  s_waitcnt vmcnt(9)
  s_barrier
  v_cvt_pk_bf16_f32 v117, v90, v91
  v_mfma_f32_16x16x32_bf16 v[200:203], a[164:167], v[40:43], v[200:203]
  ds_read_b64_tr_b16 a[190:191], v17 offset:17888
  v_mfma_f32_16x16x32_bf16 v[204:207], a[164:167], v[44:47], v[204:207]
  s_waitcnt lgkmcnt(8)
  v_exp_f32 v92, v60
  v_add_u32 v17, s48, v17
  v_mfma_f32_16x16x32_bf16 v[208:211], a[168:171], v[40:43], v[208:211]
  v_add_f32 v9, v9, v92
  v_mfma_f32_16x16x32_bf16 v[212:215], a[168:171], v[44:47], v[212:215]
  v_exp_f32 v93, v61
  v_mfma_f32_16x16x32_bf16 v[216:219], a[172:175], v[40:43], v[216:219]
  s_sub_u32 s48, 0, s48
  ds_read_b64_tr_b16 a[160:161], v17 offset:256
  v_add_f32 v9, v9, v93
  v_mfma_f32_16x16x32_bf16 v[220:223], a[172:175], v[44:47], v[220:223]
  s_waitcnt lgkmcnt(5)
  ds_read_b64_tr_b16 a[162:163], v17 offset:768
  v_cvt_pk_bf16_f32 v118, v92, v93
  v_mfma_f32_16x16x32_bf16 v[224:227], a[176:179], v[40:43], v[224:227]
  ds_read_b64_tr_b16 a[164:165], v17 offset:288
  v_exp_f32 v94, v62
  v_mfma_f32_16x16x32_bf16 v[228:231], a[176:179], v[44:47], v[228:231]
  ds_read_b64_tr_b16 a[166:167], v17 offset:800
  v_add_f32 v9, v9, v94
  v_mfma_f32_16x16x32_bf16 v[232:235], a[180:183], v[40:43], v[232:235]
  ds_read_b64_tr_b16 a[168:169], v17 offset:320
  v_exp_f32 v95, v63
  v_mfma_f32_16x16x32_bf16 v[236:239], a[180:183], v[44:47], v[236:239]
  s_waitcnt lgkmcnt(5)
  ds_read_b64_tr_b16 a[170:171], v17 offset:832
  v_add_f32 v9, v9, v95
  v_mfma_f32_16x16x32_bf16 v[240:243], a[184:187], v[40:43], v[240:243]
  v_cvt_pk_bf16_f32 v119, v94, v95
  v_max_f32 v20, v8, v9
  v_mfma_f32_16x16x32_bf16 v[244:247], a[184:187], v[44:47], v[244:247]
  ds_read_b64_tr_b16 a[172:173], v17 offset:352
  v_cmp_lt_f32 vcc, s60, v20
  v_mfma_f32_16x16x32_bf16 v[248:251], a[188:191], v[40:43], v[248:251]
  s_waitcnt lgkmcnt(3)
  ds_read_b64_tr_b16 a[174:175], v17 offset:864
  v_mfma_f32_16x16x32_bf16 v[252:255], a[188:191], v[44:47], v[252:255]
  s_cbranch_vccnz L_rare4
L_back4:
  v_mfma_f32_16x16x32_bf16 v[192:195], a[160:163], v[112:115], v[192:195]
  ds_read_b64_tr_b16 a[176:177], v17 offset:384
  ds_read_b64_tr_b16 a[178:179], v17 offset:896
  v_exp_f32 v80, v64
  v_add_f32 v22, v22, v8
  v_mfma_f32_16x16x32_bf16 v[196:199], a[160:163], v[116:119], v[196:199]
  ds_read_b64_tr_b16 a[180:181], v17 offset:416
  ds_read_b64_tr_b16 a[182:183], v17 offset:928
  v_exp_f32 v81, v65
  v_mfma_f32_16x16x32_bf16 v[200:203], a[164:167], v[112:115], v[200:203]
  ds_read_b64_tr_b16 a[184:185], v17 offset:448
  v_add_f32 v8, v80, v81
  v_cvt_pk_bf16_f32 v120, v80, v81
  v_exp_f32 v82, v66
  v_mfma_f32_16x16x32_bf16 v[204:207], a[164:167], v[116:119], v[204:207]
  s_waitcnt lgkmcnt(5)
  ds_read_b64_tr_b16 a[186:187], v17 offset:960
  ds_read_b64_tr_b16 a[188:189], v17 offset:480
  v_add_f32 v8, v8, v82
  v_exp_f32 v83, v67
  v_mfma_f32_16x16x32_bf16 v[208:211], a[168:171], v[112:115], v[208:211]
  ds_read_b64_tr_b16 a[190:191], v17 offset:992
  v_add_f32 v8, v8, v83
  v_cvt_pk_bf16_f32 v121, v82, v83
  v_exp_f32 v84, v68
  v_mfma_f32_16x16x32_bf16 v[212:215], a[168:171], v[116:119], v[212:215]
  ds_read_b64_tr_b16 a[128:129], v17 offset:34048
  ds_read_b64_tr_b16 a[130:131], v17 offset:34560
  v_add_f32 v8, v8, v84
  v_exp_f32 v85, v69
  v_mfma_f32_16x16x32_bf16 v[216:219], a[172:175], v[112:115], v[216:219]
  ds_read_b64_tr_b16 a[132:133], v17 offset:34080
  v_add_f32 v8, v8, v85
  v_cvt_pk_bf16_f32 v122, v84, v85
  v_exp_f32 v86, v70
  v_mfma_f32_16x16x32_bf16 v[220:223], a[172:175], v[116:119], v[220:223]
  s_waitcnt lgkmcnt(7)
  ds_read_b64_tr_b16 a[134:135], v17 offset:34592
  ds_read_b64_tr_b16 a[136:137], v17 offset:34112
  v_add_f32 v8, v8, v86
  v_exp_f32 v87, v71
  v_mfma_f32_16x16x32_bf16 v[224:227], a[176:179], v[112:115], v[224:227]
  v_add_f32 v8, v8, v87
  v_cvt_pk_bf16_f32 v123, v86, v87
  v_exp_f32 v88, v72
  v_add_f32 v23, v23, v9
  v_mfma_f32_16x16x32_bf16 v[228:231], a[176:179], v[116:119], v[228:231]
  ds_read_b64_tr_b16 a[138:139], v17 offset:34624
  ds_read_b64_tr_b16 a[140:141], v17 offset:34144
  ds_read_b64_tr_b16 a[142:143], v17 offset:34656
  v_exp_f32 v89, v73
  v_mfma_f32_16x16x32_bf16 v[232:235], a[180:183], v[112:115], v[232:235]
  ds_read_b64_tr_b16 a[144:145], v17 offset:34176
  v_add_f32 v9, v88, v89
  v_cvt_pk_bf16_f32 v124, v88, v89
  v_exp_f32 v90, v74
  v_mfma_f32_16x16x32_bf16 v[236:239], a[180:183], v[116:119], v[236:239]
  s_waitcnt lgkmcnt(9)
  ds_read_b64_tr_b16 a[146:147], v17 offset:34688
  ds_read_b64_tr_b16 a[148:149], v17 offset:34208
  v_add_f32 v9, v9, v90
  v_exp_f32 v91, v75
  v_mfma_f32_16x16x32_bf16 v[240:243], a[184:187], v[112:115], v[240:243]
  ds_read_b64_tr_b16 a[150:151], v17 offset:34720
  v_add_f32 v9, v9, v91
  v_cvt_pk_bf16_f32 v125, v90, v91
  v_exp_f32 v92, v76
  v_mfma_f32_16x16x32_bf16 v[244:247], a[184:187], v[116:119], v[244:247]
  ds_read_b64_tr_b16 a[152:153], v17 offset:34240
  ds_read_b64_tr_b16 a[154:155], v17 offset:34752
  v_add_f32 v9, v9, v92
  v_exp_f32 v93, v77
  v_mfma_f32_16x16x32_bf16 v[248:251], a[188:191], v[112:115], v[248:251]
  ds_read_b64_tr_b16 a[156:157], v17 offset:34272
  v_add_f32 v9, v9, v93
  v_cvt_pk_bf16_f32 v126, v92, v93
  v_exp_f32 v94, v78
  v_mfma_f32_16x16x32_bf16 v[252:255], a[188:191], v[116:119], v[252:255]
  ds_read_b64_tr_b16 a[158:159], v17 offset:34784
  v_add_f32 v9, v9, v94
  v_exp_f32 v95, v79
  s_nop 0
  v_add_f32 v9, v9, v95
  v_cvt_pk_bf16_f32 v127, v94, v95
  v_max_f32 v20, v8, v9
  v_cmp_lt_f32 vcc, 0x43800000, v20
  v_readfirstlane_b32 s52, v2
  s_nop 0
  s_cbranch_vccnz L_rare2
L_back2:
  s_and_b32 s3, s52, 0xff
  s_cmp_eq_u32 s3, s49
  s_cbranch_scc1 L_sendfast
  s_waitcnt lgkmcnt(12)
  v_mfma_f32_16x16x32_bf16 v[192:195], a[128:131], v[120:123], v[192:195]
  v_add_u32 v1, s48, v17
  v_add_f32 v22, v22, v8
  v_add_f32 v23, v23, v9
  v_mov_b32 v6, v22
  v_mov_b32 v7, v23
  v_mov_b32 v4, v24
  v_mfma_f32_16x16x32_bf16 v[196:199], a[128:131], v[124:127], v[196:199]
  v_mov_b32 v5, v28
  v_permlane16_swap_b32 v6, v22
  v_permlane16_swap_b32 v7, v23
  v_add_f32 v22, v6, v22
  v_mfma_f32_16x16x32_bf16 v[200:203], a[132:135], v[120:123], v[200:203]
  v_add_f32 v23, v7, v23
  v_mov_b32 v6, v22
  v_mov_b32 v7, v23
  s_nop 0
  v_mfma_f32_16x16x32_bf16 v[204:207], a[132:135], v[124:127], v[204:207]
  s_waitcnt lgkmcnt(8)
  v_permlane32_swap_b32 v6, v22
  v_permlane32_swap_b32 v7, v23
  v_add_f32 v6, v6, v22
  v_add_f32 v7, v7, v23
  v_mfma_f32_16x16x32_bf16 v[208:211], a[136:139], v[120:123], v[208:211]
  buffer_store_dwordx4 v[4:7], v15, s[32:35], s57 offen offset:256 sc1
  v_cvt_pk_bf16_f32 v192, v192, v193
  v_cvt_pk_bf16_f32 v193, v194, v195
  v_cvt_pk_bf16_f32 v194, v196, v197
  v_cvt_pk_bf16_f32 v195, v198, v199
  v_mfma_f32_16x16x32_bf16 v[212:215], a[136:139], v[124:127], v[212:215]
  buffer_store_dwordx4 v[192:195], v12, s[28:31], s53 offen offset:0 sc1
  ds_read_b64_tr_b16 a[160:161], v1 offset:0
  ds_read_b64_tr_b16 a[162:163], v1 offset:512
  v_mfma_f32_16x16x32_bf16 v[216:219], a[140:143], v[120:123], v[216:219]
  v_cvt_pk_bf16_f32 v200, v200, v201
  v_cvt_pk_bf16_f32 v201, v202, v203
  v_cvt_pk_bf16_f32 v202, v204, v205
  v_cvt_pk_bf16_f32 v203, v206, v207
  v_mfma_f32_16x16x32_bf16 v[220:223], a[140:143], v[124:127], v[220:223]
  s_waitcnt lgkmcnt(6)
  buffer_store_dwordx4 v[200:203], v12, s[28:31], s53 offen offset:512 sc1
  ds_read_b64_tr_b16 a[164:165], v1 offset:32
  ds_read_b64_tr_b16 a[166:167], v1 offset:544
  s_add_u32 s53, s53, 4096
  v_mfma_f32_16x16x32_bf16 v[224:227], a[144:147], v[120:123], v[224:227]
  v_cvt_pk_bf16_f32 v208, v208, v209
  v_cvt_pk_bf16_f32 v209, v210, v211
  v_cvt_pk_bf16_f32 v210, v212, v213
  v_cvt_pk_bf16_f32 v211, v214, v215
  v_mfma_f32_16x16x32_bf16 v[228:231], a[144:147], v[124:127], v[228:231]
  buffer_store_dwordx4 v[208:211], v12, s[28:31], s53 offen offset:0 sc1
  ds_read_b64_tr_b16 a[168:169], v1 offset:64
  ds_read_b64_tr_b16 a[170:171], v1 offset:576
  v_mfma_f32_16x16x32_bf16 v[232:235], a[148:151], v[120:123], v[232:235]
  v_cvt_pk_bf16_f32 v216, v216, v217
  v_cvt_pk_bf16_f32 v217, v218, v219
  v_cvt_pk_bf16_f32 v218, v220, v221
  v_cvt_pk_bf16_f32 v219, v222, v223
  v_mfma_f32_16x16x32_bf16 v[236:239], a[148:151], v[124:127], v[236:239]
  s_waitcnt lgkmcnt(6)
  buffer_store_dwordx4 v[216:219], v12, s[28:31], s53 offen offset:512 sc1
  ds_read_b64_tr_b16 a[172:173], v1 offset:96
  ds_read_b64_tr_b16 a[174:175], v1 offset:608
  s_add_u32 s53, s53, 4096
  v_mfma_f32_16x16x32_bf16 v[240:243], a[152:155], v[120:123], v[240:243]
  v_cvt_pk_bf16_f32 v224, v224, v225
  v_cvt_pk_bf16_f32 v225, v226, v227
  v_cvt_pk_bf16_f32 v226, v228, v229
  v_cvt_pk_bf16_f32 v227, v230, v231
  v_mfma_f32_16x16x32_bf16 v[244:247], a[152:155], v[124:127], v[244:247]
  buffer_store_dwordx4 v[224:227], v12, s[28:31], s53 offen offset:0 sc1
  ds_read_b64_tr_b16 a[176:177], v1 offset:128
  ds_read_b64_tr_b16 a[178:179], v1 offset:640
  v_mfma_f32_16x16x32_bf16 v[248:251], a[156:159], v[120:123], v[248:251]
  v_cvt_pk_bf16_f32 v232, v232, v233
  v_cvt_pk_bf16_f32 v233, v234, v235
  v_cvt_pk_bf16_f32 v234, v236, v237
  v_cvt_pk_bf16_f32 v235, v238, v239
  v_mfma_f32_16x16x32_bf16 v[252:255], a[156:159], v[124:127], v[252:255]
  s_waitcnt lgkmcnt(6)
  buffer_store_dwordx4 v[232:235], v12, s[28:31], s53 offen offset:512 sc1
  ds_read_b64_tr_b16 a[180:181], v1 offset:160
  ds_read_b64_tr_b16 a[182:183], v1 offset:672
  s_add_u32 s53, s53, 4096
  v_mfma_f32_16x16x32_bf16 v[128:131], a[160:163], v[32:35], v[128:131]
  v_cvt_pk_bf16_f32 v240, v240, v241
  v_cvt_pk_bf16_f32 v241, v242, v243
  v_cvt_pk_bf16_f32 v242, v244, v245
  v_cvt_pk_bf16_f32 v243, v246, v247
  v_mfma_f32_16x16x32_bf16 v[132:135], a[160:163], v[36:39], v[132:135]
  buffer_store_dwordx4 v[240:243], v12, s[28:31], s53 offen offset:0 sc1
  ds_read_b64_tr_b16 a[184:185], v1 offset:192
  ds_read_b64_tr_b16 a[186:187], v1 offset:704
  v_mfma_f32_16x16x32_bf16 v[136:139], a[164:167], v[32:35], v[136:139]
  v_cvt_pk_bf16_f32 v248, v248, v249
  v_cvt_pk_bf16_f32 v249, v250, v251
  v_cvt_pk_bf16_f32 v250, v252, v253
  v_cvt_pk_bf16_f32 v251, v254, v255
  v_mfma_f32_16x16x32_bf16 v[140:143], a[164:167], v[36:39], v[140:143]
  s_waitcnt lgkmcnt(6)
  buffer_store_dwordx4 v[248:251], v12, s[28:31], s53 offen offset:512 sc1
  ds_read_b64_tr_b16 a[188:189], v1 offset:224
  ds_read_b64_tr_b16 a[190:191], v1 offset:736
  v_mfma_f32_16x16x32_bf16 v[144:147], a[168:171], v[32:35], v[144:147]
  ds_read_b64_tr_b16 a[128:129], v1 offset:16896
  ds_read_b64_tr_b16 a[130:131], v1 offset:17408
  v_mfma_f32_16x16x32_bf16 v[148:151], a[168:171], v[36:39], v[148:151]
  ds_read_b64_tr_b16 a[132:133], v1 offset:16928
  ds_read_b64_tr_b16 a[134:135], v1 offset:17440
  v_mfma_f32_16x16x32_bf16 v[152:155], a[172:175], v[32:35], v[152:155]
  ds_read_b64_tr_b16 a[136:137], v1 offset:16960
  v_mfma_f32_16x16x32_bf16 v[156:159], a[172:175], v[36:39], v[156:159]
  s_waitcnt lgkmcnt(9)
  ds_read_b64_tr_b16 a[138:139], v1 offset:17472
  ds_read_b64_tr_b16 a[140:141], v1 offset:16992
  v_mfma_f32_16x16x32_bf16 v[160:163], a[176:179], v[32:35], v[160:163]
  ds_read_b64_tr_b16 a[142:143], v1 offset:17504
  v_mfma_f32_16x16x32_bf16 v[164:167], a[176:179], v[36:39], v[164:167]
  ds_read_b64_tr_b16 a[144:145], v1 offset:17024
  ds_read_b64_tr_b16 a[146:147], v1 offset:17536
  v_mfma_f32_16x16x32_bf16 v[168:171], a[180:183], v[32:35], v[168:171]
  ds_read_b64_tr_b16 a[148:149], v1 offset:17056
  ds_read_b64_tr_b16 a[150:151], v1 offset:17568
  v_mfma_f32_16x16x32_bf16 v[172:175], a[180:183], v[36:39], v[172:175]
  s_waitcnt lgkmcnt(12)
  ds_read_b64_tr_b16 a[152:153], v1 offset:17088
  v_mfma_f32_16x16x32_bf16 v[176:179], a[184:187], v[32:35], v[176:179]
  ds_read_b64_tr_b16 a[154:155], v1 offset:17600
  ds_read_b64_tr_b16 a[156:157], v1 offset:17120
  v_mfma_f32_16x16x32_bf16 v[180:183], a[184:187], v[36:39], v[180:183]
  ds_read_b64_tr_b16 a[158:159], v1 offset:17632
  v_mfma_f32_16x16x32_bf16 v[184:187], a[188:191], v[32:35], v[184:187]
  v_mfma_f32_16x16x32_bf16 v[188:191], a[188:191], v[36:39], v[188:191]
  s_waitcnt lgkmcnt(12)
  v_mfma_f32_16x16x32_bf16 v[128:131], a[128:131], v[40:43], v[128:131]
  v_mfma_f32_16x16x32_bf16 v[132:135], a[128:131], v[44:47], v[132:135]
  v_mfma_f32_16x16x32_bf16 v[136:139], a[132:135], v[40:43], v[136:139]
  ds_read_b64_tr_b16 a[160:161], v17 offset:0
  ds_read_b64_tr_b16 a[162:163], v17 offset:512
  v_mfma_f32_16x16x32_bf16 v[140:143], a[132:135], v[44:47], v[140:143]
  s_waitcnt lgkmcnt(10)
  ds_read_b64_tr_b16 a[164:165], v17 offset:32
  v_mfma_f32_16x16x32_bf16 v[144:147], a[136:139], v[40:43], v[144:147]
  ds_read_b64_tr_b16 a[166:167], v17 offset:544
  v_mfma_f32_16x16x32_bf16 v[148:151], a[136:139], v[44:47], v[148:151]
  ds_read_b64_tr_b16 a[168:169], v17 offset:64
  v_mfma_f32_16x16x32_bf16 v[152:155], a[140:143], v[40:43], v[152:155]
  ds_read_b64_tr_b16 a[170:171], v17 offset:576
  ds_read_b64_tr_b16 a[172:173], v17 offset:96
  v_mfma_f32_16x16x32_bf16 v[156:159], a[140:143], v[44:47], v[156:159]
  s_waitcnt lgkmcnt(11)
  ds_read_b64_tr_b16 a[174:175], v17 offset:608
  v_mfma_f32_16x16x32_bf16 v[160:163], a[144:147], v[40:43], v[160:163]
  ds_read_b64_tr_b16 a[176:177], v17 offset:128
  v_mfma_f32_16x16x32_bf16 v[164:167], a[144:147], v[44:47], v[164:167]
  ds_read_b64_tr_b16 a[178:179], v17 offset:640
  v_mfma_f32_16x16x32_bf16 v[168:171], a[148:151], v[40:43], v[168:171]
  ds_read_b64_tr_b16 a[180:181], v17 offset:160
  ds_read_b64_tr_b16 a[182:183], v17 offset:672
  v_mfma_f32_16x16x32_bf16 v[172:175], a[148:151], v[44:47], v[172:175]
  s_waitcnt lgkmcnt(12)
  ds_read_b64_tr_b16 a[184:185], v17 offset:192
  v_mfma_f32_16x16x32_bf16 v[176:179], a[152:155], v[40:43], v[176:179]
  ds_read_b64_tr_b16 a[186:187], v17 offset:704
  v_mfma_f32_16x16x32_bf16 v[180:183], a[152:155], v[44:47], v[180:183]
  ds_read_b64_tr_b16 a[188:189], v17 offset:224
  v_mfma_f32_16x16x32_bf16 v[184:187], a[156:159], v[40:43], v[184:187]
  ds_read_b64_tr_b16 a[190:191], v17 offset:736
  v_mfma_f32_16x16x32_bf16 v[188:191], a[156:159], v[44:47], v[188:191]
  s_waitcnt lgkmcnt(12)
  v_mfma_f32_16x16x32_bf16 v[128:131], a[160:163], v[112:115], v[128:131]
  v_mfma_f32_16x16x32_bf16 v[132:135], a[160:163], v[116:119], v[132:135]
  v_mfma_f32_16x16x32_bf16 v[136:139], a[164:167], v[112:115], v[136:139]
  ds_read_b64_tr_b16 a[128:129], v17 offset:33792
  ds_read_b64_tr_b16 a[130:131], v17 offset:34304
  v_mfma_f32_16x16x32_bf16 v[140:143], a[164:167], v[116:119], v[140:143]
  s_waitcnt lgkmcnt(10)
  ds_read_b64_tr_b16 a[132:133], v17 offset:33824
  v_mfma_f32_16x16x32_bf16 v[144:147], a[168:171], v[112:115], v[144:147]
  ds_read_b64_tr_b16 a[134:135], v17 offset:34336
  v_mfma_f32_16x16x32_bf16 v[148:151], a[168:171], v[116:119], v[148:151]
  ds_read_b64_tr_b16 a[136:137], v17 offset:33856
  v_mfma_f32_16x16x32_bf16 v[152:155], a[172:175], v[112:115], v[152:155]
  ds_read_b64_tr_b16 a[138:139], v17 offset:34368
  ds_read_b64_tr_b16 a[140:141], v17 offset:33888
  v_mfma_f32_16x16x32_bf16 v[156:159], a[172:175], v[116:119], v[156:159]
  s_waitcnt lgkmcnt(11)
  ds_read_b64_tr_b16 a[142:143], v17 offset:34400
  v_mfma_f32_16x16x32_bf16 v[160:163], a[176:179], v[112:115], v[160:163]
  ds_read_b64_tr_b16 a[144:145], v17 offset:33920
  v_mfma_f32_16x16x32_bf16 v[164:167], a[176:179], v[116:119], v[164:167]
  ds_read_b64_tr_b16 a[146:147], v17 offset:34432
  v_mfma_f32_16x16x32_bf16 v[168:171], a[180:183], v[112:115], v[168:171]
  ds_read_b64_tr_b16 a[148:149], v17 offset:33952
  ds_read_b64_tr_b16 a[150:151], v17 offset:34464
  v_mfma_f32_16x16x32_bf16 v[172:175], a[180:183], v[116:119], v[172:175]
  s_waitcnt lgkmcnt(12)
  ds_read_b64_tr_b16 a[152:153], v17 offset:33984
  v_mfma_f32_16x16x32_bf16 v[176:179], a[184:187], v[112:115], v[176:179]
  ds_read_b64_tr_b16 a[154:155], v17 offset:34496
  v_mfma_f32_16x16x32_bf16 v[180:183], a[184:187], v[116:119], v[180:183]
  ds_read_b64_tr_b16 a[156:157], v17 offset:34016
  v_mfma_f32_16x16x32_bf16 v[184:187], a[188:191], v[112:115], v[184:187]
  ds_read_b64_tr_b16 a[158:159], v17 offset:34528
  v_mfma_f32_16x16x32_bf16 v[188:191], a[188:191], v[116:119], v[188:191]
  s_waitcnt lgkmcnt(12)
  v_mfma_f32_16x16x32_bf16 v[128:131], a[128:131], v[120:123], v[128:131]
  v_mfma_f32_16x16x32_bf16 v[132:135], a[128:131], v[124:127], v[132:135]
  v_mfma_f32_16x16x32_bf16 v[136:139], a[132:135], v[120:123], v[136:139]
  v_mfma_f32_16x16x32_bf16 v[140:143], a[132:135], v[124:127], v[140:143]
  s_waitcnt lgkmcnt(8)
  v_mfma_f32_16x16x32_bf16 v[144:147], a[136:139], v[120:123], v[144:147]
  s_waitcnt vmcnt(0)
  buffer_store_dword v2, v3, s[32:35], s57 offen sc1
  v_mfma_f32_16x16x32_bf16 v[148:151], a[136:139], v[124:127], v[148:151]
  v_mfma_f32_16x16x32_bf16 v[152:155], a[140:143], v[120:123], v[152:155]
  v_mfma_f32_16x16x32_bf16 v[156:159], a[140:143], v[124:127], v[156:159]
  s_waitcnt lgkmcnt(4)
  v_mfma_f32_16x16x32_bf16 v[160:163], a[144:147], v[120:123], v[160:163]
  v_mfma_f32_16x16x32_bf16 v[164:167], a[144:147], v[124:127], v[164:167]
  v_mfma_f32_16x16x32_bf16 v[168:171], a[148:151], v[120:123], v[168:171]
  v_mfma_f32_16x16x32_bf16 v[172:175], a[148:151], v[124:127], v[172:175]
  s_waitcnt lgkmcnt(0)
  v_mfma_f32_16x16x32_bf16 v[176:179], a[152:155], v[120:123], v[176:179]
  v_mfma_f32_16x16x32_bf16 v[180:183], a[152:155], v[124:127], v[180:183]
  v_mfma_f32_16x16x32_bf16 v[184:187], a[156:159], v[120:123], v[184:187]
  v_mfma_f32_16x16x32_bf16 v[188:191], a[156:159], v[124:127], v[188:191]
  s_branch L_sent
L_sendfast:
  s_waitcnt lgkmcnt(12)
  v_mfma_f32_16x16x32_bf16 v[192:195], a[128:131], v[120:123], v[192:195]
  v_add_u32 v1, s48, v17
  v_add_f32 v22, v22, v8
  v_add_f32 v23, v23, v9
  v_mov_b32 v6, v22
  v_mov_b32 v7, v23
  v_mov_b32 v4, v24
  v_mfma_f32_16x16x32_bf16 v[196:199], a[128:131], v[124:127], v[196:199]
  v_mov_b32 v5, v28
  v_permlane16_swap_b32 v6, v22
  v_permlane16_swap_b32 v7, v23
  v_add_f32 v22, v6, v22
  v_mfma_f32_16x16x32_bf16 v[200:203], a[132:135], v[120:123], v[200:203]
  v_add_f32 v23, v7, v23
  v_mov_b32 v6, v22
  v_mov_b32 v7, v23
  s_nop 0
  v_mfma_f32_16x16x32_bf16 v[204:207], a[132:135], v[124:127], v[204:207]
  s_waitcnt lgkmcnt(8)
  v_permlane32_swap_b32 v6, v22
  v_permlane32_swap_b32 v7, v23
  v_add_f32 v6, v6, v22
  v_add_f32 v7, v7, v23
  v_mfma_f32_16x16x32_bf16 v[208:211], a[136:139], v[120:123], v[208:211]
  buffer_store_dwordx4 v[4:7], v15, s[32:35], s57 offen offset:256
  v_cvt_pk_bf16_f32 v192, v192, v193
  v_cvt_pk_bf16_f32 v193, v194, v195
  v_cvt_pk_bf16_f32 v194, v196, v197
  v_cvt_pk_bf16_f32 v195, v198, v199
  v_mfma_f32_16x16x32_bf16 v[212:215], a[136:139], v[124:127], v[212:215]
  buffer_store_dwordx4 v[192:195], v12, s[28:31], s53 offen offset:0
  ds_read_b64_tr_b16 a[160:161], v1 offset:0
  ds_read_b64_tr_b16 a[162:163], v1 offset:512
  v_mfma_f32_16x16x32_bf16 v[216:219], a[140:143], v[120:123], v[216:219]
  v_cvt_pk_bf16_f32 v200, v200, v201
  v_cvt_pk_bf16_f32 v201, v202, v203
  v_cvt_pk_bf16_f32 v202, v204, v205
  v_cvt_pk_bf16_f32 v203, v206, v207
  v_mfma_f32_16x16x32_bf16 v[220:223], a[140:143], v[124:127], v[220:223]
  s_waitcnt lgkmcnt(6)
  buffer_store_dwordx4 v[200:203], v12, s[28:31], s53 offen offset:512
  ds_read_b64_tr_b16 a[164:165], v1 offset:32
  ds_read_b64_tr_b16 a[166:167], v1 offset:544
  s_add_u32 s53, s53, 4096
  v_mfma_f32_16x16x32_bf16 v[224:227], a[144:147], v[120:123], v[224:227]
  v_cvt_pk_bf16_f32 v208, v208, v209
  v_cvt_pk_bf16_f32 v209, v210, v211
  v_cvt_pk_bf16_f32 v210, v212, v213
  v_cvt_pk_bf16_f32 v211, v214, v215
  v_mfma_f32_16x16x32_bf16 v[228:231], a[144:147], v[124:127], v[228:231]
  buffer_store_dwordx4 v[208:211], v12, s[28:31], s53 offen offset:0
  ds_read_b64_tr_b16 a[168:169], v1 offset:64
  ds_read_b64_tr_b16 a[170:171], v1 offset:576
  v_mfma_f32_16x16x32_bf16 v[232:235], a[148:151], v[120:123], v[232:235]
  v_cvt_pk_bf16_f32 v216, v216, v217
  v_cvt_pk_bf16_f32 v217, v218, v219
  v_cvt_pk_bf16_f32 v218, v220, v221
  v_cvt_pk_bf16_f32 v219, v222, v223
  v_mfma_f32_16x16x32_bf16 v[236:239], a[148:151], v[124:127], v[236:239]
  s_waitcnt lgkmcnt(6)
  buffer_store_dwordx4 v[216:219], v12, s[28:31], s53 offen offset:512
  ds_read_b64_tr_b16 a[172:173], v1 offset:96
  ds_read_b64_tr_b16 a[174:175], v1 offset:608
  s_add_u32 s53, s53, 4096
  v_mfma_f32_16x16x32_bf16 v[240:243], a[152:155], v[120:123], v[240:243]
  v_cvt_pk_bf16_f32 v224, v224, v225
  v_cvt_pk_bf16_f32 v225, v226, v227
  v_cvt_pk_bf16_f32 v226, v228, v229
  v_cvt_pk_bf16_f32 v227, v230, v231
  v_mfma_f32_16x16x32_bf16 v[244:247], a[152:155], v[124:127], v[244:247]
  buffer_store_dwordx4 v[224:227], v12, s[28:31], s53 offen offset:0
  ds_read_b64_tr_b16 a[176:177], v1 offset:128
  ds_read_b64_tr_b16 a[178:179], v1 offset:640
  v_mfma_f32_16x16x32_bf16 v[248:251], a[156:159], v[120:123], v[248:251]
  v_cvt_pk_bf16_f32 v232, v232, v233
  v_cvt_pk_bf16_f32 v233, v234, v235
  v_cvt_pk_bf16_f32 v234, v236, v237
  v_cvt_pk_bf16_f32 v235, v238, v239
  v_mfma_f32_16x16x32_bf16 v[252:255], a[156:159], v[124:127], v[252:255]
  s_waitcnt lgkmcnt(6)
  buffer_store_dwordx4 v[232:235], v12, s[28:31], s53 offen offset:512
  ds_read_b64_tr_b16 a[180:181], v1 offset:160
  ds_read_b64_tr_b16 a[182:183], v1 offset:672
  s_add_u32 s53, s53, 4096
  v_mfma_f32_16x16x32_bf16 v[128:131], a[160:163], v[32:35], v[128:131]
  v_cvt_pk_bf16_f32 v240, v240, v241
  v_cvt_pk_bf16_f32 v241, v242, v243
  v_cvt_pk_bf16_f32 v242, v244, v245
  v_cvt_pk_bf16_f32 v243, v246, v247
  v_mfma_f32_16x16x32_bf16 v[132:135], a[160:163], v[36:39], v[132:135]
  buffer_store_dwordx4 v[240:243], v12, s[28:31], s53 offen offset:0
  ds_read_b64_tr_b16 a[184:185], v1 offset:192
  ds_read_b64_tr_b16 a[186:187], v1 offset:704
  v_mfma_f32_16x16x32_bf16 v[136:139], a[164:167], v[32:35], v[136:139]
  v_cvt_pk_bf16_f32 v248, v248, v249
  v_cvt_pk_bf16_f32 v249, v250, v251
  v_cvt_pk_bf16_f32 v250, v252, v253
  v_cvt_pk_bf16_f32 v251, v254, v255
  v_mfma_f32_16x16x32_bf16 v[140:143], a[164:167], v[36:39], v[140:143]
  s_waitcnt lgkmcnt(6)
  buffer_store_dwordx4 v[248:251], v12, s[28:31], s53 offen offset:512
  ds_read_b64_tr_b16 a[188:189], v1 offset:224
  ds_read_b64_tr_b16 a[190:191], v1 offset:736
  v_mfma_f32_16x16x32_bf16 v[144:147], a[168:171], v[32:35], v[144:147]
  ds_read_b64_tr_b16 a[128:129], v1 offset:16896
  ds_read_b64_tr_b16 a[130:131], v1 offset:17408
  v_mfma_f32_16x16x32_bf16 v[148:151], a[168:171], v[36:39], v[148:151]
  ds_read_b64_tr_b16 a[132:133], v1 offset:16928
  ds_read_b64_tr_b16 a[134:135], v1 offset:17440
  v_mfma_f32_16x16x32_bf16 v[152:155], a[172:175], v[32:35], v[152:155]
  ds_read_b64_tr_b16 a[136:137], v1 offset:16960
  v_mfma_f32_16x16x32_bf16 v[156:159], a[172:175], v[36:39], v[156:159]
  s_waitcnt lgkmcnt(9)
  ds_read_b64_tr_b16 a[138:139], v1 offset:17472
  ds_read_b64_tr_b16 a[140:141], v1 offset:16992
  v_mfma_f32_16x16x32_bf16 v[160:163], a[176:179], v[32:35], v[160:163]
  ds_read_b64_tr_b16 a[142:143], v1 offset:17504
  v_mfma_f32_16x16x32_bf16 v[164:167], a[176:179], v[36:39], v[164:167]
  ds_read_b64_tr_b16 a[144:145], v1 offset:17024
  ds_read_b64_tr_b16 a[146:147], v1 offset:17536
  v_mfma_f32_16x16x32_bf16 v[168:171], a[180:183], v[32:35], v[168:171]
  ds_read_b64_tr_b16 a[148:149], v1 offset:17056
  ds_read_b64_tr_b16 a[150:151], v1 offset:17568
  v_mfma_f32_16x16x32_bf16 v[172:175], a[180:183], v[36:39], v[172:175]
  s_waitcnt lgkmcnt(12)
  ds_read_b64_tr_b16 a[152:153], v1 offset:17088
  v_mfma_f32_16x16x32_bf16 v[176:179], a[184:187], v[32:35], v[176:179]
  ds_read_b64_tr_b16 a[154:155], v1 offset:17600
  ds_read_b64_tr_b16 a[156:157], v1 offset:17120
  v_mfma_f32_16x16x32_bf16 v[180:183], a[184:187], v[36:39], v[180:183]
  ds_read_b64_tr_b16 a[158:159], v1 offset:17632
  v_mfma_f32_16x16x32_bf16 v[184:187], a[188:191], v[32:35], v[184:187]
  v_mfma_f32_16x16x32_bf16 v[188:191], a[188:191], v[36:39], v[188:191]
  s_waitcnt lgkmcnt(12)
  v_mfma_f32_16x16x32_bf16 v[128:131], a[128:131], v[40:43], v[128:131]
  v_mfma_f32_16x16x32_bf16 v[132:135], a[128:131], v[44:47], v[132:135]
  v_mfma_f32_16x16x32_bf16 v[136:139], a[132:135], v[40:43], v[136:139]
  ds_read_b64_tr_b16 a[160:161], v17 offset:0
  ds_read_b64_tr_b16 a[162:163], v17 offset:512
  v_mfma_f32_16x16x32_bf16 v[140:143], a[132:135], v[44:47], v[140:143]
  s_waitcnt lgkmcnt(10)
  ds_read_b64_tr_b16 a[164:165], v17 offset:32
  v_mfma_f32_16x16x32_bf16 v[144:147], a[136:139], v[40:43], v[144:147]
  ds_read_b64_tr_b16 a[166:167], v17 offset:544
  v_mfma_f32_16x16x32_bf16 v[148:151], a[136:139], v[44:47], v[148:151]
  ds_read_b64_tr_b16 a[168:169], v17 offset:64
  v_mfma_f32_16x16x32_bf16 v[152:155], a[140:143], v[40:43], v[152:155]
  ds_read_b64_tr_b16 a[170:171], v17 offset:576
  ds_read_b64_tr_b16 a[172:173], v17 offset:96
  v_mfma_f32_16x16x32_bf16 v[156:159], a[140:143], v[44:47], v[156:159]
  s_waitcnt lgkmcnt(11)
  ds_read_b64_tr_b16 a[174:175], v17 offset:608
  v_mfma_f32_16x16x32_bf16 v[160:163], a[144:147], v[40:43], v[160:163]
  ds_read_b64_tr_b16 a[176:177], v17 offset:128
  v_mfma_f32_16x16x32_bf16 v[164:167], a[144:147], v[44:47], v[164:167]
  ds_read_b64_tr_b16 a[178:179], v17 offset:640
  v_mfma_f32_16x16x32_bf16 v[168:171], a[148:151], v[40:43], v[168:171]
  ds_read_b64_tr_b16 a[180:181], v17 offset:160
  ds_read_b64_tr_b16 a[182:183], v17 offset:672
  v_mfma_f32_16x16x32_bf16 v[172:175], a[148:151], v[44:47], v[172:175]
  s_waitcnt lgkmcnt(12)
  ds_read_b64_tr_b16 a[184:185], v17 offset:192
  v_mfma_f32_16x16x32_bf16 v[176:179], a[152:155], v[40:43], v[176:179]
  ds_read_b64_tr_b16 a[186:187], v17 offset:704
  v_mfma_f32_16x16x32_bf16 v[180:183], a[152:155], v[44:47], v[180:183]
  ds_read_b64_tr_b16 a[188:189], v17 offset:224
  v_mfma_f32_16x16x32_bf16 v[184:187], a[156:159], v[40:43], v[184:187]
  ds_read_b64_tr_b16 a[190:191], v17 offset:736
  v_mfma_f32_16x16x32_bf16 v[188:191], a[156:159], v[44:47], v[188:191]
  s_waitcnt lgkmcnt(12)
  v_mfma_f32_16x16x32_bf16 v[128:131], a[160:163], v[112:115], v[128:131]
  v_mfma_f32_16x16x32_bf16 v[132:135], a[160:163], v[116:119], v[132:135]
  v_mfma_f32_16x16x32_bf16 v[136:139], a[164:167], v[112:115], v[136:139]
  ds_read_b64_tr_b16 a[128:129], v17 offset:33792
  ds_read_b64_tr_b16 a[130:131], v17 offset:34304
  v_mfma_f32_16x16x32_bf16 v[140:143], a[164:167], v[116:119], v[140:143]
  s_waitcnt lgkmcnt(10)
  ds_read_b64_tr_b16 a[132:133], v17 offset:33824
  v_mfma_f32_16x16x32_bf16 v[144:147], a[168:171], v[112:115], v[144:147]
  ds_read_b64_tr_b16 a[134:135], v17 offset:34336
  v_mfma_f32_16x16x32_bf16 v[148:151], a[168:171], v[116:119], v[148:151]
  ds_read_b64_tr_b16 a[136:137], v17 offset:33856
  v_mfma_f32_16x16x32_bf16 v[152:155], a[172:175], v[112:115], v[152:155]
  ds_read_b64_tr_b16 a[138:139], v17 offset:34368
  ds_read_b64_tr_b16 a[140:141], v17 offset:33888
  v_mfma_f32_16x16x32_bf16 v[156:159], a[172:175], v[116:119], v[156:159]
  s_waitcnt lgkmcnt(11)
  ds_read_b64_tr_b16 a[142:143], v17 offset:34400
  v_mfma_f32_16x16x32_bf16 v[160:163], a[176:179], v[112:115], v[160:163]
  ds_read_b64_tr_b16 a[144:145], v17 offset:33920
  v_mfma_f32_16x16x32_bf16 v[164:167], a[176:179], v[116:119], v[164:167]
  ds_read_b64_tr_b16 a[146:147], v17 offset:34432
  v_mfma_f32_16x16x32_bf16 v[168:171], a[180:183], v[112:115], v[168:171]
  ds_read_b64_tr_b16 a[148:149], v17 offset:33952
  ds_read_b64_tr_b16 a[150:151], v17 offset:34464
  v_mfma_f32_16x16x32_bf16 v[172:175], a[180:183], v[116:119], v[172:175]
  s_waitcnt lgkmcnt(12)
  ds_read_b64_tr_b16 a[152:153], v17 offset:33984
  v_mfma_f32_16x16x32_bf16 v[176:179], a[184:187], v[112:115], v[176:179]
  ds_read_b64_tr_b16 a[154:155], v17 offset:34496
  v_mfma_f32_16x16x32_bf16 v[180:183], a[184:187], v[116:119], v[180:183]
  ds_read_b64_tr_b16 a[156:157], v17 offset:34016
  v_mfma_f32_16x16x32_bf16 v[184:187], a[188:191], v[112:115], v[184:187]
  ds_read_b64_tr_b16 a[158:159], v17 offset:34528
  v_mfma_f32_16x16x32_bf16 v[188:191], a[188:191], v[116:119], v[188:191]
  s_waitcnt lgkmcnt(12)
  v_mfma_f32_16x16x32_bf16 v[128:131], a[128:131], v[120:123], v[128:131]
  v_mfma_f32_16x16x32_bf16 v[132:135], a[128:131], v[124:127], v[132:135]
  v_mfma_f32_16x16x32_bf16 v[136:139], a[132:135], v[120:123], v[136:139]
  v_mfma_f32_16x16x32_bf16 v[140:143], a[132:135], v[124:127], v[140:143]
  s_waitcnt lgkmcnt(8)
  v_mfma_f32_16x16x32_bf16 v[144:147], a[136:139], v[120:123], v[144:147]
  s_waitcnt vmcnt(0)
  buffer_store_dword v2, v3, s[32:35], s57 offen
  v_mfma_f32_16x16x32_bf16 v[148:151], a[136:139], v[124:127], v[148:151]
  v_mfma_f32_16x16x32_bf16 v[152:155], a[140:143], v[120:123], v[152:155]
  v_mfma_f32_16x16x32_bf16 v[156:159], a[140:143], v[124:127], v[156:159]
  s_waitcnt lgkmcnt(4)
  v_mfma_f32_16x16x32_bf16 v[160:163], a[144:147], v[120:123], v[160:163]
  v_mfma_f32_16x16x32_bf16 v[164:167], a[144:147], v[124:127], v[164:167]
  v_mfma_f32_16x16x32_bf16 v[168:171], a[148:151], v[120:123], v[168:171]
  v_mfma_f32_16x16x32_bf16 v[172:175], a[148:151], v[124:127], v[172:175]
  s_waitcnt lgkmcnt(0)
  v_mfma_f32_16x16x32_bf16 v[176:179], a[152:155], v[120:123], v[176:179]
  v_mfma_f32_16x16x32_bf16 v[180:183], a[152:155], v[124:127], v[180:183]
  v_mfma_f32_16x16x32_bf16 v[184:187], a[156:159], v[120:123], v[184:187]
  v_mfma_f32_16x16x32_bf16 v[188:191], a[156:159], v[124:127], v[188:191]
L_sent:
  s_mov_b32 s45, 0x200000
L_poll:
  s_sub_u32 s45, s45, 1
  s_cbranch_scc1 L_pollok
  buffer_load_dword v8, v3, s[32:35], s58 offen sc1
  s_waitcnt vmcnt(0)
  v_readfirstlane_b32 s3, v8
  s_nop 1
  s_cmp_lg_u32 s3, s59
  s_cbranch_scc1 L_poll
L_pollok:
  s_mov_b32 s53, s54
  buffer_load_dwordx4 v[32:35], v15, s[32:35], s58 offen offset:256 sc1
  buffer_load_dwordx4 v[96:99], v12, s[28:31], s53 offen offset:0 sc1
  buffer_load_dwordx4 v[100:103], v12, s[28:31], s53 offen offset:512 sc1
  s_add_u32 s53, s53, 4096
  buffer_load_dwordx4 v[104:107], v12, s[28:31], s53 offen offset:0 sc1
  buffer_load_dwordx4 v[108:111], v12, s[28:31], s53 offen offset:512 sc1
  s_add_u32 s53, s53, 4096
  buffer_load_dwordx4 v[112:115], v12, s[28:31], s53 offen offset:0 sc1
  buffer_load_dwordx4 v[116:119], v12, s[28:31], s53 offen offset:512 sc1
  s_add_u32 s53, s53, 4096
  buffer_load_dwordx4 v[120:123], v12, s[28:31], s53 offen offset:0 sc1
  buffer_load_dwordx4 v[124:127], v12, s[28:31], s53 offen offset:512 sc1
  buffer_load_dword v2, v3, s[32:35], s57 offen offset:128 sc1
  s_waitcnt vmcnt(9)
  v_min_f32 v44, v4, v32
  v_sub_f32 v36, v44, v4
  v_sub_f32 v40, v44, v32
  v_exp_f32 v36, v36
  v_exp_f32 v40, v40
  v_min_f32 v45, v5, v33
  v_sub_f32 v38, v45, v5
  v_sub_f32 v42, v45, v33
  v_exp_f32 v38, v38
  v_exp_f32 v42, v42
  v_mul_f32 v44, v36, v6
  v_fma_f32 v44, v40, v34, v44
  v_rcp_f32 v44, v44
  v_mul_f32 v45, v38, v7
  v_fma_f32 v45, v42, v35, v45
  v_rcp_f32 v45, v45
  v_mul_f32 v36, v36, v44
  v_mul_f32 v40, v40, v44
  v_mul_f32 v38, v38, v45
  v_mul_f32 v42, v42, v45
  v_pk_mul_f32 v[128:129], v[128:129], v[36:37] op_sel_hi:[1,0]
  v_pk_mul_f32 v[130:131], v[130:131], v[36:37] op_sel_hi:[1,0]
  v_pk_mul_f32 v[132:133], v[132:133], v[38:39] op_sel_hi:[1,0]
  v_pk_mul_f32 v[134:135], v[134:135], v[38:39] op_sel_hi:[1,0]
  v_pk_mul_f32 v[136:137], v[136:137], v[36:37] op_sel_hi:[1,0]
  v_pk_mul_f32 v[138:139], v[138:139], v[36:37] op_sel_hi:[1,0]
  v_pk_mul_f32 v[140:141], v[140:141], v[38:39] op_sel_hi:[1,0]
  v_pk_mul_f32 v[142:143], v[142:143], v[38:39] op_sel_hi:[1,0]
  v_pk_mul_f32 v[144:145], v[144:145], v[36:37] op_sel_hi:[1,0]
  v_pk_mul_f32 v[146:147], v[146:147], v[36:37] op_sel_hi:[1,0]
  v_pk_mul_f32 v[148:149], v[148:149], v[38:39] op_sel_hi:[1,0]
  v_pk_mul_f32 v[150:151], v[150:151], v[38:39] op_sel_hi:[1,0]
  v_pk_mul_f32 v[152:153], v[152:153], v[36:37] op_sel_hi:[1,0]
  v_pk_mul_f32 v[154:155], v[154:155], v[36:37] op_sel_hi:[1,0]
  v_pk_mul_f32 v[156:157], v[156:157], v[38:39] op_sel_hi:[1,0]
  v_pk_mul_f32 v[158:159], v[158:159], v[38:39] op_sel_hi:[1,0]
  v_pk_mul_f32 v[160:161], v[160:161], v[36:37] op_sel_hi:[1,0]
  v_pk_mul_f32 v[162:163], v[162:163], v[36:37] op_sel_hi:[1,0]
  v_pk_mul_f32 v[164:165], v[164:165], v[38:39] op_sel_hi:[1,0]
  v_pk_mul_f32 v[166:167], v[166:167], v[38:39] op_sel_hi:[1,0]
  v_pk_mul_f32 v[168:169], v[168:169], v[36:37] op_sel_hi:[1,0]
  v_pk_mul_f32 v[170:171], v[170:171], v[36:37] op_sel_hi:[1,0]
  v_pk_mul_f32 v[172:173], v[172:173], v[38:39] op_sel_hi:[1,0]
  v_pk_mul_f32 v[174:175], v[174:175], v[38:39] op_sel_hi:[1,0]
  v_pk_mul_f32 v[176:177], v[176:177], v[36:37] op_sel_hi:[1,0]
  v_pk_mul_f32 v[178:179], v[178:179], v[36:37] op_sel_hi:[1,0]
  v_pk_mul_f32 v[180:181], v[180:181], v[38:39] op_sel_hi:[1,0]
  v_pk_mul_f32 v[182:183], v[182:183], v[38:39] op_sel_hi:[1,0]
  v_pk_mul_f32 v[184:185], v[184:185], v[36:37] op_sel_hi:[1,0]
  v_pk_mul_f32 v[186:187], v[186:187], v[36:37] op_sel_hi:[1,0]
  v_pk_mul_f32 v[188:189], v[188:189], v[38:39] op_sel_hi:[1,0]
  v_pk_mul_f32 v[190:191], v[190:191], v[38:39] op_sel_hi:[1,0]
  s_add_u32 s53, s54, 8192
  s_waitcnt vmcnt(8)
  v_lshlrev_b32 v48, 16, v96
  v_and_b32 v49, 0xffff0000, v96
  v_lshlrev_b32 v50, 16, v97
  v_and_b32 v51, 0xffff0000, v97
  v_pk_fma_f32 v[128:129], v[48:49], v[40:41], v[128:129] op_sel_hi:[1,0,1]
  v_pk_fma_f32 v[130:131], v[50:51], v[40:41], v[130:131] op_sel_hi:[1,0,1]
  v_cvt_pk_bf16_f32 v128, v128, v129
  v_cvt_pk_bf16_f32 v129, v130, v131
  s_waitcnt vmcnt(7)
  v_lshlrev_b32 v56, 16, v100
  v_and_b32 v57, 0xffff0000, v100
  v_lshlrev_b32 v58, 16, v101
  v_and_b32 v59, 0xffff0000, v101
  v_pk_fma_f32 v[136:137], v[56:57], v[40:41], v[136:137] op_sel_hi:[1,0,1]
  v_pk_fma_f32 v[138:139], v[58:59], v[40:41], v[138:139] op_sel_hi:[1,0,1]
  v_cvt_pk_bf16_f32 v136, v136, v137
  v_cvt_pk_bf16_f32 v137, v138, v139
  s_waitcnt vmcnt(6)
  v_lshlrev_b32 v48, 16, v104
  v_and_b32 v49, 0xffff0000, v104
  v_lshlrev_b32 v50, 16, v105
  v_and_b32 v51, 0xffff0000, v105
  v_pk_fma_f32 v[144:145], v[48:49], v[40:41], v[144:145] op_sel_hi:[1,0,1]
  v_pk_fma_f32 v[146:147], v[50:51], v[40:41], v[146:147] op_sel_hi:[1,0,1]
  v_cvt_pk_bf16_f32 v144, v144, v145
  v_cvt_pk_bf16_f32 v145, v146, v147
  s_waitcnt vmcnt(5)
  v_lshlrev_b32 v56, 16, v108
  v_and_b32 v57, 0xffff0000, v108
  v_lshlrev_b32 v58, 16, v109
  v_and_b32 v59, 0xffff0000, v109
  v_pk_fma_f32 v[152:153], v[56:57], v[40:41], v[152:153] op_sel_hi:[1,0,1]
  v_pk_fma_f32 v[154:155], v[58:59], v[40:41], v[154:155] op_sel_hi:[1,0,1]
  v_cvt_pk_bf16_f32 v152, v152, v153
  v_cvt_pk_bf16_f32 v153, v154, v155
  ds_write_b64 v13, v[128:129] offset:0
  ds_write_b64 v13, v[136:137] offset:32
  ds_write_b64 v13, v[144:145] offset:64
  ds_write_b64 v13, v[152:153] offset:96
  ds_read_b128 v[192:195], v14 offset:0
  ds_read_b128 v[196:199], v14 offset:2176
  s_waitcnt vmcnt(1)
  v_lshlrev_b32 v52, 16, v98
  v_and_b32 v53, 0xffff0000, v98
  v_lshlrev_b32 v54, 16, v99
  v_and_b32 v55, 0xffff0000, v99
  v_pk_fma_f32 v[132:133], v[52:53], v[42:43], v[132:133] op_sel_hi:[1,0,1]
  v_pk_fma_f32 v[134:135], v[54:55], v[42:43], v[134:135] op_sel_hi:[1,0,1]
  v_cvt_pk_bf16_f32 v132, v132, v133
  v_cvt_pk_bf16_f32 v133, v134, v135
  v_lshlrev_b32 v60, 16, v102
  v_and_b32 v61, 0xffff0000, v102
  v_lshlrev_b32 v62, 16, v103
  v_and_b32 v63, 0xffff0000, v103
  v_pk_fma_f32 v[140:141], v[60:61], v[42:43], v[140:141] op_sel_hi:[1,0,1]
  v_pk_fma_f32 v[142:143], v[62:63], v[42:43], v[142:143] op_sel_hi:[1,0,1]
  v_cvt_pk_bf16_f32 v140, v140, v141
  v_cvt_pk_bf16_f32 v141, v142, v143
  s_waitcnt lgkmcnt(1)
  buffer_store_dwordx4 v[192:195], v21, s[28:31], s54 offen offset:0
  v_lshlrev_b32 v52, 16, v106
  v_and_b32 v53, 0xffff0000, v106
  v_lshlrev_b32 v54, 16, v107
  v_and_b32 v55, 0xffff0000, v107
  v_pk_fma_f32 v[148:149], v[52:53], v[42:43], v[148:149] op_sel_hi:[1,0,1]
  v_pk_fma_f32 v[150:151], v[54:55], v[42:43], v[150:151] op_sel_hi:[1,0,1]
  v_cvt_pk_bf16_f32 v148, v148, v149
  v_cvt_pk_bf16_f32 v149, v150, v151
  s_waitcnt lgkmcnt(0)
  buffer_store_dwordx4 v[196:199], v21, s[28:31], s53 offen offset:0
  v_lshlrev_b32 v60, 16, v110
  v_and_b32 v61, 0xffff0000, v110
  v_lshlrev_b32 v62, 16, v111
  v_and_b32 v63, 0xffff0000, v111
  v_pk_fma_f32 v[156:157], v[60:61], v[42:43], v[156:157] op_sel_hi:[1,0,1]
  v_pk_fma_f32 v[158:159], v[62:63], v[42:43], v[158:159] op_sel_hi:[1,0,1]
  v_cvt_pk_bf16_f32 v156, v156, v157
  v_cvt_pk_bf16_f32 v157, v158, v159
  ds_write_b64 v13, v[132:133] offset:4352
  ds_write_b64 v13, v[140:141] offset:4384
  ds_write_b64 v13, v[148:149] offset:4416
  ds_write_b64 v13, v[156:157] offset:4448
  ds_read_b128 v[200:203], v14 offset:4352
  ds_read_b128 v[204:207], v14 offset:6528
  v_lshlrev_b32 v48, 16, v112
  v_and_b32 v49, 0xffff0000, v112
  v_lshlrev_b32 v50, 16, v113
  v_and_b32 v51, 0xffff0000, v113
  v_pk_fma_f32 v[160:161], v[48:49], v[40:41], v[160:161] op_sel_hi:[1,0,1]
  v_pk_fma_f32 v[162:163], v[50:51], v[40:41], v[162:163] op_sel_hi:[1,0,1]
  v_cvt_pk_bf16_f32 v160, v160, v161
  v_cvt_pk_bf16_f32 v161, v162, v163
  v_lshlrev_b32 v56, 16, v116
  v_and_b32 v57, 0xffff0000, v116
  v_lshlrev_b32 v58, 16, v117
  v_and_b32 v59, 0xffff0000, v117
  v_pk_fma_f32 v[168:169], v[56:57], v[40:41], v[168:169] op_sel_hi:[1,0,1]
  v_pk_fma_f32 v[170:171], v[58:59], v[40:41], v[170:171] op_sel_hi:[1,0,1]
  v_cvt_pk_bf16_f32 v168, v168, v169
  v_cvt_pk_bf16_f32 v169, v170, v171
  s_waitcnt lgkmcnt(1)
  buffer_store_dwordx4 v[200:203], v21, s[28:31], s54 offen offset:512
  v_lshlrev_b32 v48, 16, v120
  v_and_b32 v49, 0xffff0000, v120
  v_lshlrev_b32 v50, 16, v121
  v_and_b32 v51, 0xffff0000, v121
  v_pk_fma_f32 v[176:177], v[48:49], v[40:41], v[176:177] op_sel_hi:[1,0,1]
  v_pk_fma_f32 v[178:179], v[50:51], v[40:41], v[178:179] op_sel_hi:[1,0,1]
  v_cvt_pk_bf16_f32 v176, v176, v177
  v_cvt_pk_bf16_f32 v177, v178, v179
  s_waitcnt lgkmcnt(0)
  buffer_store_dwordx4 v[204:207], v21, s[28:31], s53 offen offset:512
  v_lshlrev_b32 v56, 16, v124
  v_and_b32 v57, 0xffff0000, v124
  v_lshlrev_b32 v58, 16, v125
  v_and_b32 v59, 0xffff0000, v125
  v_pk_fma_f32 v[184:185], v[56:57], v[40:41], v[184:185] op_sel_hi:[1,0,1]
  v_pk_fma_f32 v[186:187], v[58:59], v[40:41], v[186:187] op_sel_hi:[1,0,1]
  v_cvt_pk_bf16_f32 v184, v184, v185
  v_cvt_pk_bf16_f32 v185, v186, v187
  ds_write_b64 v13, v[160:161] offset:128
  ds_write_b64 v13, v[168:169] offset:160
  ds_write_b64 v13, v[176:177] offset:192
  ds_write_b64 v13, v[184:185] offset:224
  ds_read_b128 v[208:211], v14 offset:128
  ds_read_b128 v[212:215], v14 offset:2304
  v_lshlrev_b32 v52, 16, v114
  v_and_b32 v53, 0xffff0000, v114
  v_lshlrev_b32 v54, 16, v115
  v_and_b32 v55, 0xffff0000, v115
  v_pk_fma_f32 v[164:165], v[52:53], v[42:43], v[164:165] op_sel_hi:[1,0,1]
  v_pk_fma_f32 v[166:167], v[54:55], v[42:43], v[166:167] op_sel_hi:[1,0,1]
  v_cvt_pk_bf16_f32 v164, v164, v165
  v_cvt_pk_bf16_f32 v165, v166, v167
  v_lshlrev_b32 v60, 16, v118
  v_and_b32 v61, 0xffff0000, v118
  v_lshlrev_b32 v62, 16, v119
  v_and_b32 v63, 0xffff0000, v119
  v_pk_fma_f32 v[172:173], v[60:61], v[42:43], v[172:173] op_sel_hi:[1,0,1]
  v_pk_fma_f32 v[174:175], v[62:63], v[42:43], v[174:175] op_sel_hi:[1,0,1]
  v_cvt_pk_bf16_f32 v172, v172, v173
  v_cvt_pk_bf16_f32 v173, v174, v175
  s_waitcnt lgkmcnt(1)
  buffer_store_dwordx4 v[208:211], v21, s[28:31], s54 offen offset:128
  v_lshlrev_b32 v52, 16, v122
  v_and_b32 v53, 0xffff0000, v122
  v_lshlrev_b32 v54, 16, v123
  v_and_b32 v55, 0xffff0000, v123
  v_pk_fma_f32 v[180:181], v[52:53], v[42:43], v[180:181] op_sel_hi:[1,0,1]
  v_pk_fma_f32 v[182:183], v[54:55], v[42:43], v[182:183] op_sel_hi:[1,0,1]
  v_cvt_pk_bf16_f32 v180, v180, v181
  v_cvt_pk_bf16_f32 v181, v182, v183
  s_waitcnt lgkmcnt(0)
  buffer_store_dwordx4 v[212:215], v21, s[28:31], s53 offen offset:128
  v_lshlrev_b32 v60, 16, v126
  v_and_b32 v61, 0xffff0000, v126
  v_lshlrev_b32 v62, 16, v127
  v_and_b32 v63, 0xffff0000, v127
  v_pk_fma_f32 v[188:189], v[60:61], v[42:43], v[188:189] op_sel_hi:[1,0,1]
  v_pk_fma_f32 v[190:191], v[62:63], v[42:43], v[190:191] op_sel_hi:[1,0,1]
  v_cvt_pk_bf16_f32 v188, v188, v189
  v_cvt_pk_bf16_f32 v189, v190, v191
  ds_write_b64 v13, v[164:165] offset:4480
  ds_write_b64 v13, v[172:173] offset:4512
  ds_write_b64 v13, v[180:181] offset:4544
  ds_write_b64 v13, v[188:189] offset:4576
  ds_read_b128 v[216:219], v14 offset:4480
  ds_read_b128 v[220:223], v14 offset:6656
  s_waitcnt lgkmcnt(1)
  buffer_store_dwordx4 v[216:219], v21, s[28:31], s54 offen offset:640
  s_waitcnt lgkmcnt(0)
  buffer_store_dwordx4 v[220:223], v21, s[28:31], s53 offen offset:640
  s_waitcnt vmcnt(8)
  v_readfirstlane_b32 s3, v2
  s_nop 1
  s_cmp_eq_u32 s3, s52
  s_cbranch_scc1 L_tagok
  buffer_wbl2 sc1
  s_waitcnt vmcnt(0)
  buffer_store_dword v2, v3, s[32:35], s57 offen sc1
L_tagok:
L_end:
  s_endpgm
L_rare0:
  v_max3_f32 v1, v64, v65, v66
  v_max3_f32 v1, v1, v67, v68
  v_max3_f32 v1, v1, v69, v70
  v_max3_f32 v1, v1, v71, 0
  v_max3_f32 v4, v72, v73, v74
  v_max3_f32 v4, v4, v75, v76
  v_max3_f32 v4, v4, v77, v78
  v_max3_f32 v4, v4, v79, 0
  v_mov_b32 v6, v1
  v_mov_b32 v7, v4
  s_nop 0
  v_permlane16_swap_b32 v6, v1
  v_permlane16_swap_b32 v7, v4
  v_max_f32 v1, v1, v6
  v_max_f32 v4, v4, v7
  v_mov_b32 v6, v1
  v_mov_b32 v7, v4
  s_nop 0
  v_permlane32_swap_b32 v6, v1
  v_permlane32_swap_b32 v7, v4
  v_max_f32 v1, v1, v6
  v_max_f32 v4, v4, v7
  v_exp_f32 v6, -v1
  v_exp_f32 v7, -v4
  v_sub_f32 v24, v24, v1
  v_sub_f32 v25, v25, v1
  v_sub_f32 v26, v26, v1
  v_sub_f32 v27, v27, v1
  v_sub_f32 v64, v64, v1
  v_sub_f32 v65, v65, v1
  v_sub_f32 v66, v66, v1
  v_sub_f32 v67, v67, v1
  v_sub_f32 v68, v68, v1
  v_sub_f32 v69, v69, v1
  v_sub_f32 v70, v70, v1
  v_sub_f32 v71, v71, v1
  v_sub_f32 v48, v48, v1
  v_sub_f32 v49, v49, v1
  v_sub_f32 v50, v50, v1
  v_sub_f32 v51, v51, v1
  v_sub_f32 v52, v52, v1
  v_sub_f32 v53, v53, v1
  v_sub_f32 v54, v54, v1
  v_sub_f32 v55, v55, v1
  v_mul_f32 v22, v6, v22
  v_sub_f32 v28, v28, v4
  v_sub_f32 v29, v29, v4
  v_sub_f32 v30, v30, v4
  v_sub_f32 v31, v31, v4
  v_sub_f32 v72, v72, v4
  v_sub_f32 v73, v73, v4
  v_sub_f32 v74, v74, v4
  v_sub_f32 v75, v75, v4
  v_sub_f32 v76, v76, v4
  v_sub_f32 v77, v77, v4
  v_sub_f32 v78, v78, v4
  v_sub_f32 v79, v79, v4
  v_sub_f32 v56, v56, v4
  v_sub_f32 v57, v57, v4
  v_sub_f32 v58, v58, v4
  v_sub_f32 v59, v59, v4
  v_sub_f32 v60, v60, v4
  v_sub_f32 v61, v61, v4
  v_sub_f32 v62, v62, v4
  v_sub_f32 v63, v63, v4
  v_mul_f32 v23, v7, v23
  v_exp_f32 v80, v64
  v_exp_f32 v81, v65
  v_exp_f32 v82, v66
  v_add_f32 v8, v80, v81
  v_cvt_pk_bf16_f32 v40, v80, v81
  v_exp_f32 v83, v67
  v_add_f32 v8, v8, v82
  v_exp_f32 v84, v68
  v_add_f32 v8, v8, v83
  v_cvt_pk_bf16_f32 v41, v82, v83
  v_exp_f32 v85, v69
  v_add_f32 v8, v8, v84
  v_exp_f32 v86, v70
  v_add_f32 v8, v8, v85
  v_cvt_pk_bf16_f32 v42, v84, v85
  v_exp_f32 v87, v71
  v_add_f32 v8, v8, v86
  v_exp_f32 v88, v72
  v_add_f32 v8, v8, v87
  v_cvt_pk_bf16_f32 v43, v86, v87
  v_exp_f32 v89, v73
  v_exp_f32 v90, v74
  v_add_f32 v9, v88, v89
  v_cvt_pk_bf16_f32 v44, v88, v89
  v_exp_f32 v91, v75
  v_add_f32 v9, v9, v90
  v_exp_f32 v92, v76
  v_add_f32 v9, v9, v91
  v_cvt_pk_bf16_f32 v45, v90, v91
  v_exp_f32 v93, v77
  v_add_f32 v9, v9, v92
  v_exp_f32 v94, v78
  v_add_f32 v9, v9, v93
  v_cvt_pk_bf16_f32 v46, v92, v93
  v_exp_f32 v95, v79
  v_add_f32 v9, v9, v94
  v_add_f32 v9, v9, v95
  v_cvt_pk_bf16_f32 v47, v94, v95
  v_mul_f32 v128, v6, v128
  v_mul_f32 v129, v6, v129
  v_mul_f32 v130, v6, v130
  v_mul_f32 v131, v6, v131
  v_mul_f32 v132, v7, v132
  v_mul_f32 v133, v7, v133
  v_mul_f32 v134, v7, v134
  v_mul_f32 v135, v7, v135
  v_mul_f32 v136, v6, v136
  v_mul_f32 v137, v6, v137
  v_mul_f32 v138, v6, v138
  v_mul_f32 v139, v6, v139
  v_mul_f32 v140, v7, v140
  v_mul_f32 v141, v7, v141
  v_mul_f32 v142, v7, v142
  v_mul_f32 v143, v7, v143
  v_mul_f32 v144, v6, v144
  v_mul_f32 v145, v6, v145
  v_mul_f32 v146, v6, v146
  v_mul_f32 v147, v6, v147
  v_mul_f32 v148, v7, v148
  v_mul_f32 v149, v7, v149
  v_mul_f32 v150, v7, v150
  v_mul_f32 v151, v7, v151
  v_mul_f32 v152, v6, v152
  v_mul_f32 v153, v6, v153
  v_mul_f32 v154, v6, v154
  v_mul_f32 v155, v6, v155
  v_mul_f32 v156, v7, v156
  v_mul_f32 v157, v7, v157
  v_mul_f32 v158, v7, v158
  v_mul_f32 v159, v7, v159
  v_mul_f32 v160, v6, v160
  v_mul_f32 v161, v6, v161
  v_mul_f32 v162, v6, v162
  v_mul_f32 v163, v6, v163
  v_mul_f32 v164, v7, v164
  v_mul_f32 v165, v7, v165
  v_mul_f32 v166, v7, v166
  v_mul_f32 v167, v7, v167
  v_mul_f32 v168, v6, v168
  v_mul_f32 v169, v6, v169
  v_mul_f32 v170, v6, v170
  v_mul_f32 v171, v6, v171
  v_mul_f32 v172, v7, v172
  v_mul_f32 v173, v7, v173
  v_mul_f32 v174, v7, v174
  v_mul_f32 v175, v7, v175
  v_mul_f32 v176, v6, v176
  v_mul_f32 v177, v6, v177
  v_mul_f32 v178, v6, v178
  v_mul_f32 v179, v6, v179
  v_mul_f32 v180, v7, v180
  v_mul_f32 v181, v7, v181
  v_mul_f32 v182, v7, v182
  v_mul_f32 v183, v7, v183
  v_mul_f32 v184, v6, v184
  v_mul_f32 v185, v6, v185
  v_mul_f32 v186, v6, v186
  v_mul_f32 v187, v6, v187
  v_mul_f32 v188, v7, v188
  v_mul_f32 v189, v7, v189
  v_mul_f32 v190, v7, v190
  v_mul_f32 v191, v7, v191
  v_mul_f32 v192, v6, v192
  v_mul_f32 v193, v6, v193
  v_mul_f32 v194, v6, v194
  v_mul_f32 v195, v6, v195
  v_mul_f32 v196, v7, v196
  v_mul_f32 v197, v7, v197
  v_mul_f32 v198, v7, v198
  v_mul_f32 v199, v7, v199
  v_mul_f32 v200, v6, v200
  v_mul_f32 v201, v6, v201
  v_mul_f32 v202, v6, v202
  v_mul_f32 v203, v6, v203
  v_mul_f32 v204, v7, v204
  v_mul_f32 v205, v7, v205
  v_mul_f32 v206, v7, v206
  v_mul_f32 v207, v7, v207
  v_mul_f32 v208, v6, v208
  v_mul_f32 v209, v6, v209
  v_mul_f32 v210, v6, v210
  v_mul_f32 v211, v6, v211
  v_mul_f32 v212, v7, v212
  v_mul_f32 v213, v7, v213
  v_mul_f32 v214, v7, v214
  v_mul_f32 v215, v7, v215
  v_mul_f32 v216, v6, v216
  v_mul_f32 v217, v6, v217
  v_mul_f32 v218, v6, v218
  v_mul_f32 v219, v6, v219
  v_mul_f32 v220, v7, v220
  v_mul_f32 v221, v7, v221
  v_mul_f32 v222, v7, v222
  v_mul_f32 v223, v7, v223
  v_mul_f32 v224, v6, v224
  v_mul_f32 v225, v6, v225
  v_mul_f32 v226, v6, v226
  v_mul_f32 v227, v6, v227
  v_mul_f32 v228, v7, v228
  v_mul_f32 v229, v7, v229
  v_mul_f32 v230, v7, v230
  v_mul_f32 v231, v7, v231
  v_mul_f32 v232, v6, v232
  v_mul_f32 v233, v6, v233
  v_mul_f32 v234, v6, v234
  v_mul_f32 v235, v6, v235
  v_mul_f32 v236, v7, v236
  v_mul_f32 v237, v7, v237
  v_mul_f32 v238, v7, v238
  v_mul_f32 v239, v7, v239
  v_mul_f32 v240, v6, v240
  v_mul_f32 v241, v6, v241
  v_mul_f32 v242, v6, v242
  v_mul_f32 v243, v6, v243
  v_mul_f32 v244, v7, v244
  v_mul_f32 v245, v7, v245
  v_mul_f32 v246, v7, v246
  v_mul_f32 v247, v7, v247
  v_mul_f32 v248, v6, v248
  v_mul_f32 v249, v6, v249
  v_mul_f32 v250, v6, v250
  v_mul_f32 v251, v6, v251
  v_mul_f32 v252, v7, v252
  v_mul_f32 v253, v7, v253
  v_mul_f32 v254, v7, v254
  v_mul_f32 v255, v7, v255
  s_nop 1
  s_branch L_back0
L_rare1:
  v_max3_f32 v1, v48, v49, v50
  v_max3_f32 v1, v1, v51, v52
  v_max3_f32 v1, v1, v53, v54
  v_max3_f32 v1, v1, v55, 0
  v_max3_f32 v4, v56, v57, v58
  v_max3_f32 v4, v4, v59, v60
  v_max3_f32 v4, v4, v61, v62
  v_max3_f32 v4, v4, v63, 0
  v_mov_b32 v6, v1
  v_mov_b32 v7, v4
  s_nop 0
  v_permlane16_swap_b32 v6, v1
  v_permlane16_swap_b32 v7, v4
  v_max_f32 v1, v1, v6
  v_max_f32 v4, v4, v7
  v_mov_b32 v6, v1
  v_mov_b32 v7, v4
  s_nop 0
  v_permlane32_swap_b32 v6, v1
  v_permlane32_swap_b32 v7, v4
  v_max_f32 v1, v1, v6
  v_max_f32 v4, v4, v7
  v_exp_f32 v6, -v1
  v_exp_f32 v7, -v4
  v_sub_f32 v24, v24, v1
  v_sub_f32 v25, v25, v1
  v_sub_f32 v26, v26, v1
  v_sub_f32 v27, v27, v1
  v_sub_f32 v48, v48, v1
  v_sub_f32 v49, v49, v1
  v_sub_f32 v50, v50, v1
  v_sub_f32 v51, v51, v1
  v_sub_f32 v52, v52, v1
  v_sub_f32 v53, v53, v1
  v_sub_f32 v54, v54, v1
  v_sub_f32 v55, v55, v1
  v_sub_f32 v64, v64, v1
  v_sub_f32 v65, v65, v1
  v_sub_f32 v66, v66, v1
  v_sub_f32 v67, v67, v1
  v_sub_f32 v68, v68, v1
  v_sub_f32 v69, v69, v1
  v_sub_f32 v70, v70, v1
  v_sub_f32 v71, v71, v1
  v_mul_f32 v22, v6, v22
  v_sub_f32 v28, v28, v4
  v_sub_f32 v29, v29, v4
  v_sub_f32 v30, v30, v4
  v_sub_f32 v31, v31, v4
  v_sub_f32 v56, v56, v4
  v_sub_f32 v57, v57, v4
  v_sub_f32 v58, v58, v4
  v_sub_f32 v59, v59, v4
  v_sub_f32 v60, v60, v4
  v_sub_f32 v61, v61, v4
  v_sub_f32 v62, v62, v4
  v_sub_f32 v63, v63, v4
  v_sub_f32 v72, v72, v4
  v_sub_f32 v73, v73, v4
  v_sub_f32 v74, v74, v4
  v_sub_f32 v75, v75, v4
  v_sub_f32 v76, v76, v4
  v_sub_f32 v77, v77, v4
  v_sub_f32 v78, v78, v4
  v_sub_f32 v79, v79, v4
  v_mul_f32 v23, v7, v23
  v_exp_f32 v80, v48
  v_exp_f32 v81, v49
  v_exp_f32 v82, v50
  v_add_f32 v8, v80, v81
  v_cvt_pk_bf16_f32 v32, v80, v81
  v_exp_f32 v83, v51
  v_add_f32 v8, v8, v82
  v_exp_f32 v84, v52
  v_add_f32 v8, v8, v83
  v_cvt_pk_bf16_f32 v33, v82, v83
  v_exp_f32 v85, v53
  v_add_f32 v8, v8, v84
  v_exp_f32 v86, v54
  v_add_f32 v8, v8, v85
  v_cvt_pk_bf16_f32 v34, v84, v85
  v_exp_f32 v87, v55
  v_add_f32 v8, v8, v86
  v_exp_f32 v88, v56
  v_add_f32 v8, v8, v87
  v_cvt_pk_bf16_f32 v35, v86, v87
  v_exp_f32 v89, v57
  v_exp_f32 v90, v58
  v_add_f32 v9, v88, v89
  v_cvt_pk_bf16_f32 v36, v88, v89
  v_exp_f32 v91, v59
  v_add_f32 v9, v9, v90
  v_exp_f32 v92, v60
  v_add_f32 v9, v9, v91
  v_cvt_pk_bf16_f32 v37, v90, v91
  v_exp_f32 v93, v61
  v_add_f32 v9, v9, v92
  v_exp_f32 v94, v62
  v_add_f32 v9, v9, v93
  v_cvt_pk_bf16_f32 v38, v92, v93
  v_exp_f32 v95, v63
  v_add_f32 v9, v9, v94
  v_add_f32 v9, v9, v95
  v_cvt_pk_bf16_f32 v39, v94, v95
  v_mul_f32 v128, v6, v128
  v_mul_f32 v129, v6, v129
  v_mul_f32 v130, v6, v130
  v_mul_f32 v131, v6, v131
  v_mul_f32 v132, v7, v132
  v_mul_f32 v133, v7, v133
  v_mul_f32 v134, v7, v134
  v_mul_f32 v135, v7, v135
  v_mul_f32 v136, v6, v136
  v_mul_f32 v137, v6, v137
  v_mul_f32 v138, v6, v138
  v_mul_f32 v139, v6, v139
  v_mul_f32 v140, v7, v140
  v_mul_f32 v141, v7, v141
  v_mul_f32 v142, v7, v142
  v_mul_f32 v143, v7, v143
  v_mul_f32 v144, v6, v144
  v_mul_f32 v145, v6, v145
  v_mul_f32 v146, v6, v146
  v_mul_f32 v147, v6, v147
  v_mul_f32 v148, v7, v148
  v_mul_f32 v149, v7, v149
  v_mul_f32 v150, v7, v150
  v_mul_f32 v151, v7, v151
  v_mul_f32 v152, v6, v152
  v_mul_f32 v153, v6, v153
  v_mul_f32 v154, v6, v154
  v_mul_f32 v155, v6, v155
  v_mul_f32 v156, v7, v156
  v_mul_f32 v157, v7, v157
  v_mul_f32 v158, v7, v158
  v_mul_f32 v159, v7, v159
  v_mul_f32 v160, v6, v160
  v_mul_f32 v161, v6, v161
  v_mul_f32 v162, v6, v162
  v_mul_f32 v163, v6, v163
  v_mul_f32 v164, v7, v164
  v_mul_f32 v165, v7, v165
  v_mul_f32 v166, v7, v166
  v_mul_f32 v167, v7, v167
  v_mul_f32 v168, v6, v168
  v_mul_f32 v169, v6, v169
  v_mul_f32 v170, v6, v170
  v_mul_f32 v171, v6, v171
  v_mul_f32 v172, v7, v172
  v_mul_f32 v173, v7, v173
  v_mul_f32 v174, v7, v174
  v_mul_f32 v175, v7, v175
  v_mul_f32 v176, v6, v176
  v_mul_f32 v177, v6, v177
  v_mul_f32 v178, v6, v178
  v_mul_f32 v179, v6, v179
  v_mul_f32 v180, v7, v180
  v_mul_f32 v181, v7, v181
  v_mul_f32 v182, v7, v182
  v_mul_f32 v183, v7, v183
  v_mul_f32 v184, v6, v184
  v_mul_f32 v185, v6, v185
  v_mul_f32 v186, v6, v186
  v_mul_f32 v187, v6, v187
  v_mul_f32 v188, v7, v188
  v_mul_f32 v189, v7, v189
  v_mul_f32 v190, v7, v190
  v_mul_f32 v191, v7, v191
  v_mul_f32 v192, v6, v192
  v_mul_f32 v193, v6, v193
  v_mul_f32 v194, v6, v194
  v_mul_f32 v195, v6, v195
  v_mul_f32 v196, v7, v196
  v_mul_f32 v197, v7, v197
  v_mul_f32 v198, v7, v198
  v_mul_f32 v199, v7, v199
  v_mul_f32 v200, v6, v200
  v_mul_f32 v201, v6, v201
  v_mul_f32 v202, v6, v202
  v_mul_f32 v203, v6, v203
  v_mul_f32 v204, v7, v204
  v_mul_f32 v205, v7, v205
  v_mul_f32 v206, v7, v206
  v_mul_f32 v207, v7, v207
  v_mul_f32 v208, v6, v208
  v_mul_f32 v209, v6, v209
  v_mul_f32 v210, v6, v210
  v_mul_f32 v211, v6, v211
  v_mul_f32 v212, v7, v212
  v_mul_f32 v213, v7, v213
  v_mul_f32 v214, v7, v214
  v_mul_f32 v215, v7, v215
  v_mul_f32 v216, v6, v216
  v_mul_f32 v217, v6, v217
  v_mul_f32 v218, v6, v218
  v_mul_f32 v219, v6, v219
  v_mul_f32 v220, v7, v220
  v_mul_f32 v221, v7, v221
  v_mul_f32 v222, v7, v222
  v_mul_f32 v223, v7, v223
  v_mul_f32 v224, v6, v224
  v_mul_f32 v225, v6, v225
  v_mul_f32 v226, v6, v226
  v_mul_f32 v227, v6, v227
  v_mul_f32 v228, v7, v228
  v_mul_f32 v229, v7, v229
  v_mul_f32 v230, v7, v230
  v_mul_f32 v231, v7, v231
  v_mul_f32 v232, v6, v232
  v_mul_f32 v233, v6, v233
  v_mul_f32 v234, v6, v234
  v_mul_f32 v235, v6, v235
  v_mul_f32 v236, v7, v236
  v_mul_f32 v237, v7, v237
  v_mul_f32 v238, v7, v238
  v_mul_f32 v239, v7, v239
  v_mul_f32 v240, v6, v240
  v_mul_f32 v241, v6, v241
  v_mul_f32 v242, v6, v242
  v_mul_f32 v243, v6, v243
  v_mul_f32 v244, v7, v244
  v_mul_f32 v245, v7, v245
  v_mul_f32 v246, v7, v246
  v_mul_f32 v247, v7, v247
  v_mul_f32 v248, v6, v248
  v_mul_f32 v249, v6, v249
  v_mul_f32 v250, v6, v250
  v_mul_f32 v251, v6, v251
  v_mul_f32 v252, v7, v252
  v_mul_f32 v253, v7, v253
  v_mul_f32 v254, v7, v254
  v_mul_f32 v255, v7, v255
  s_nop 1
  s_branch L_back1
L_rare2:
  v_max3_f32 v1, v64, v65, v66
  v_max3_f32 v1, v1, v67, v68
  v_max3_f32 v1, v1, v69, v70
  v_max3_f32 v1, v1, v71, 0
  v_max3_f32 v4, v72, v73, v74
  v_max3_f32 v4, v4, v75, v76
  v_max3_f32 v4, v4, v77, v78
  v_max3_f32 v4, v4, v79, 0
  v_mov_b32 v6, v1
  v_mov_b32 v7, v4
  s_nop 0
  v_permlane16_swap_b32 v6, v1
  v_permlane16_swap_b32 v7, v4
  v_max_f32 v1, v1, v6
  v_max_f32 v4, v4, v7
  v_mov_b32 v6, v1
  v_mov_b32 v7, v4
  s_nop 0
  v_permlane32_swap_b32 v6, v1
  v_permlane32_swap_b32 v7, v4
  v_max_f32 v1, v1, v6
  v_max_f32 v4, v4, v7
  v_exp_f32 v6, -v1
  v_exp_f32 v7, -v4
  v_sub_f32 v24, v24, v1
  v_sub_f32 v25, v25, v1
  v_sub_f32 v26, v26, v1
  v_sub_f32 v27, v27, v1
  v_sub_f32 v64, v64, v1
  v_sub_f32 v65, v65, v1
  v_sub_f32 v66, v66, v1
  v_sub_f32 v67, v67, v1
  v_sub_f32 v68, v68, v1
  v_sub_f32 v69, v69, v1
  v_sub_f32 v70, v70, v1
  v_sub_f32 v71, v71, v1
  v_mul_f32 v22, v6, v22
  v_sub_f32 v28, v28, v4
  v_sub_f32 v29, v29, v4
  v_sub_f32 v30, v30, v4
  v_sub_f32 v31, v31, v4
  v_sub_f32 v72, v72, v4
  v_sub_f32 v73, v73, v4
  v_sub_f32 v74, v74, v4
  v_sub_f32 v75, v75, v4
  v_sub_f32 v76, v76, v4
  v_sub_f32 v77, v77, v4
  v_sub_f32 v78, v78, v4
  v_sub_f32 v79, v79, v4
  v_mul_f32 v23, v7, v23
  v_lshlrev_b32 v80, 16, v32
  v_and_b32 v81, 0xffff0000, v32
  v_mul_f32 v80, v6, v80
  v_mul_f32 v81, v6, v81
  v_cvt_pk_bf16_f32 v32, v80, v81
  v_lshlrev_b32 v80, 16, v33
  v_and_b32 v81, 0xffff0000, v33
  v_mul_f32 v80, v6, v80
  v_mul_f32 v81, v6, v81
  v_cvt_pk_bf16_f32 v33, v80, v81
  v_lshlrev_b32 v80, 16, v34
  v_and_b32 v81, 0xffff0000, v34
  v_mul_f32 v80, v6, v80
  v_mul_f32 v81, v6, v81
  v_cvt_pk_bf16_f32 v34, v80, v81
  v_lshlrev_b32 v80, 16, v35
  v_and_b32 v81, 0xffff0000, v35
  v_mul_f32 v80, v6, v80
  v_mul_f32 v81, v6, v81
  v_cvt_pk_bf16_f32 v35, v80, v81
  v_lshlrev_b32 v80, 16, v36
  v_and_b32 v81, 0xffff0000, v36
  v_mul_f32 v80, v7, v80
  v_mul_f32 v81, v7, v81
  v_cvt_pk_bf16_f32 v36, v80, v81
  v_lshlrev_b32 v80, 16, v37
  v_and_b32 v81, 0xffff0000, v37
  v_mul_f32 v80, v7, v80
  v_mul_f32 v81, v7, v81
  v_cvt_pk_bf16_f32 v37, v80, v81
  v_lshlrev_b32 v80, 16, v38
  v_and_b32 v81, 0xffff0000, v38
  v_mul_f32 v80, v7, v80
  v_mul_f32 v81, v7, v81
  v_cvt_pk_bf16_f32 v38, v80, v81
  v_lshlrev_b32 v80, 16, v39
  v_and_b32 v81, 0xffff0000, v39
  v_mul_f32 v80, v7, v80
  v_mul_f32 v81, v7, v81
  v_cvt_pk_bf16_f32 v39, v80, v81
  v_lshlrev_b32 v80, 16, v40
  v_and_b32 v81, 0xffff0000, v40
  v_mul_f32 v80, v6, v80
  v_mul_f32 v81, v6, v81
  v_cvt_pk_bf16_f32 v40, v80, v81
  v_lshlrev_b32 v80, 16, v41
  v_and_b32 v81, 0xffff0000, v41
  v_mul_f32 v80, v6, v80
  v_mul_f32 v81, v6, v81
  v_cvt_pk_bf16_f32 v41, v80, v81
  v_lshlrev_b32 v80, 16, v42
  v_and_b32 v81, 0xffff0000, v42
  v_mul_f32 v80, v6, v80
  v_mul_f32 v81, v6, v81
  v_cvt_pk_bf16_f32 v42, v80, v81
  v_lshlrev_b32 v80, 16, v43
  v_and_b32 v81, 0xffff0000, v43
  v_mul_f32 v80, v6, v80
  v_mul_f32 v81, v6, v81
  v_cvt_pk_bf16_f32 v43, v80, v81
  v_lshlrev_b32 v80, 16, v44
  v_and_b32 v81, 0xffff0000, v44
  v_mul_f32 v80, v7, v80
  v_mul_f32 v81, v7, v81
  v_cvt_pk_bf16_f32 v44, v80, v81
  v_lshlrev_b32 v80, 16, v45
  v_and_b32 v81, 0xffff0000, v45
  v_mul_f32 v80, v7, v80
  v_mul_f32 v81, v7, v81
  v_cvt_pk_bf16_f32 v45, v80, v81
  v_lshlrev_b32 v80, 16, v46
  v_and_b32 v81, 0xffff0000, v46
  v_mul_f32 v80, v7, v80
  v_mul_f32 v81, v7, v81
  v_cvt_pk_bf16_f32 v46, v80, v81
  v_lshlrev_b32 v80, 16, v47
  v_and_b32 v81, 0xffff0000, v47
  v_mul_f32 v80, v7, v80
  v_mul_f32 v81, v7, v81
  v_cvt_pk_bf16_f32 v47, v80, v81
  v_lshlrev_b32 v80, 16, v112
  v_and_b32 v81, 0xffff0000, v112
  v_mul_f32 v80, v6, v80
  v_mul_f32 v81, v6, v81
  v_cvt_pk_bf16_f32 v112, v80, v81
  v_lshlrev_b32 v80, 16, v113
  v_and_b32 v81, 0xffff0000, v113
  v_mul_f32 v80, v6, v80
  v_mul_f32 v81, v6, v81
  v_cvt_pk_bf16_f32 v113, v80, v81
  v_lshlrev_b32 v80, 16, v114
  v_and_b32 v81, 0xffff0000, v114
  v_mul_f32 v80, v6, v80
  v_mul_f32 v81, v6, v81
  v_cvt_pk_bf16_f32 v114, v80, v81
  v_lshlrev_b32 v80, 16, v115
  v_and_b32 v81, 0xffff0000, v115
  v_mul_f32 v80, v6, v80
  v_mul_f32 v81, v6, v81
  v_cvt_pk_bf16_f32 v115, v80, v81
  v_lshlrev_b32 v80, 16, v116
  v_and_b32 v81, 0xffff0000, v116
  v_mul_f32 v80, v7, v80
  v_mul_f32 v81, v7, v81
  v_cvt_pk_bf16_f32 v116, v80, v81
  v_lshlrev_b32 v80, 16, v117
  v_and_b32 v81, 0xffff0000, v117
  v_mul_f32 v80, v7, v80
  v_mul_f32 v81, v7, v81
  v_cvt_pk_bf16_f32 v117, v80, v81
  v_lshlrev_b32 v80, 16, v118
  v_and_b32 v81, 0xffff0000, v118
  v_mul_f32 v80, v7, v80
  v_mul_f32 v81, v7, v81
  v_cvt_pk_bf16_f32 v118, v80, v81
  v_lshlrev_b32 v80, 16, v119
  v_and_b32 v81, 0xffff0000, v119
  v_mul_f32 v80, v7, v80
  v_mul_f32 v81, v7, v81
  v_cvt_pk_bf16_f32 v119, v80, v81
  v_exp_f32 v80, v64
  v_exp_f32 v81, v65
  v_exp_f32 v82, v66
  v_add_f32 v8, v80, v81
  v_cvt_pk_bf16_f32 v120, v80, v81
  v_exp_f32 v83, v67
  v_add_f32 v8, v8, v82
  v_exp_f32 v84, v68
  v_add_f32 v8, v8, v83
  v_cvt_pk_bf16_f32 v121, v82, v83
  v_exp_f32 v85, v69
  v_add_f32 v8, v8, v84
  v_exp_f32 v86, v70
  v_add_f32 v8, v8, v85
  v_cvt_pk_bf16_f32 v122, v84, v85
  v_exp_f32 v87, v71
  v_add_f32 v8, v8, v86
  v_exp_f32 v88, v72
  v_add_f32 v8, v8, v87
  v_cvt_pk_bf16_f32 v123, v86, v87
  v_exp_f32 v89, v73
  v_exp_f32 v90, v74
  v_add_f32 v9, v88, v89
  v_cvt_pk_bf16_f32 v124, v88, v89
  v_exp_f32 v91, v75
  v_add_f32 v9, v9, v90
  v_exp_f32 v92, v76
  v_add_f32 v9, v9, v91
  v_cvt_pk_bf16_f32 v125, v90, v91
  v_exp_f32 v93, v77
  v_add_f32 v9, v9, v92
  v_exp_f32 v94, v78
  v_add_f32 v9, v9, v93
  v_cvt_pk_bf16_f32 v126, v92, v93
  v_exp_f32 v95, v79
  v_add_f32 v9, v9, v94
  v_add_f32 v9, v9, v95
  v_cvt_pk_bf16_f32 v127, v94, v95
  v_mul_f32 v128, v6, v128
  v_mul_f32 v129, v6, v129
  v_mul_f32 v130, v6, v130
  v_mul_f32 v131, v6, v131
  v_mul_f32 v132, v7, v132
  v_mul_f32 v133, v7, v133
  v_mul_f32 v134, v7, v134
  v_mul_f32 v135, v7, v135
  v_mul_f32 v136, v6, v136
  v_mul_f32 v137, v6, v137
  v_mul_f32 v138, v6, v138
  v_mul_f32 v139, v6, v139
  v_mul_f32 v140, v7, v140
  v_mul_f32 v141, v7, v141
  v_mul_f32 v142, v7, v142
  v_mul_f32 v143, v7, v143
  v_mul_f32 v144, v6, v144
  v_mul_f32 v145, v6, v145
  v_mul_f32 v146, v6, v146
  v_mul_f32 v147, v6, v147
  v_mul_f32 v148, v7, v148
  v_mul_f32 v149, v7, v149
  v_mul_f32 v150, v7, v150
  v_mul_f32 v151, v7, v151
  v_mul_f32 v152, v6, v152
  v_mul_f32 v153, v6, v153
  v_mul_f32 v154, v6, v154
  v_mul_f32 v155, v6, v155
  v_mul_f32 v156, v7, v156
  v_mul_f32 v157, v7, v157
  v_mul_f32 v158, v7, v158
  v_mul_f32 v159, v7, v159
  v_mul_f32 v160, v6, v160
  v_mul_f32 v161, v6, v161
  v_mul_f32 v162, v6, v162
  v_mul_f32 v163, v6, v163
  v_mul_f32 v164, v7, v164
  v_mul_f32 v165, v7, v165
  v_mul_f32 v166, v7, v166
  v_mul_f32 v167, v7, v167
  v_mul_f32 v168, v6, v168
  v_mul_f32 v169, v6, v169
  v_mul_f32 v170, v6, v170
  v_mul_f32 v171, v6, v171
  v_mul_f32 v172, v7, v172
  v_mul_f32 v173, v7, v173
  v_mul_f32 v174, v7, v174
  v_mul_f32 v175, v7, v175
  v_mul_f32 v176, v6, v176
  v_mul_f32 v177, v6, v177
  v_mul_f32 v178, v6, v178
  v_mul_f32 v179, v6, v179
  v_mul_f32 v180, v7, v180
  v_mul_f32 v181, v7, v181
  v_mul_f32 v182, v7, v182
  v_mul_f32 v183, v7, v183
  v_mul_f32 v184, v6, v184
  v_mul_f32 v185, v6, v185
  v_mul_f32 v186, v6, v186
  v_mul_f32 v187, v6, v187
  v_mul_f32 v188, v7, v188
  v_mul_f32 v189, v7, v189
  v_mul_f32 v190, v7, v190
  v_mul_f32 v191, v7, v191
  v_mul_f32 v192, v6, v192
  v_mul_f32 v193, v6, v193
  v_mul_f32 v194, v6, v194
  v_mul_f32 v195, v6, v195
  v_mul_f32 v196, v7, v196
  v_mul_f32 v197, v7, v197
  v_mul_f32 v198, v7, v198
  v_mul_f32 v199, v7, v199
  v_mul_f32 v200, v6, v200
  v_mul_f32 v201, v6, v201
  v_mul_f32 v202, v6, v202
  v_mul_f32 v203, v6, v203
  v_mul_f32 v204, v7, v204
  v_mul_f32 v205, v7, v205
  v_mul_f32 v206, v7, v206
  v_mul_f32 v207, v7, v207
  v_mul_f32 v208, v6, v208
  v_mul_f32 v209, v6, v209
  v_mul_f32 v210, v6, v210
  v_mul_f32 v211, v6, v211
  v_mul_f32 v212, v7, v212
  v_mul_f32 v213, v7, v213
  v_mul_f32 v214, v7, v214
  v_mul_f32 v215, v7, v215
  v_mul_f32 v216, v6, v216
  v_mul_f32 v217, v6, v217
  v_mul_f32 v218, v6, v218
  v_mul_f32 v219, v6, v219
  v_mul_f32 v220, v7, v220
  v_mul_f32 v221, v7, v221
  v_mul_f32 v222, v7, v222
  v_mul_f32 v223, v7, v223
  v_mul_f32 v224, v6, v224
  v_mul_f32 v225, v6, v225
  v_mul_f32 v226, v6, v226
  v_mul_f32 v227, v6, v227
  v_mul_f32 v228, v7, v228
  v_mul_f32 v229, v7, v229
  v_mul_f32 v230, v7, v230
  v_mul_f32 v231, v7, v231
  v_mul_f32 v232, v6, v232
  v_mul_f32 v233, v6, v233
  v_mul_f32 v234, v6, v234
  v_mul_f32 v235, v6, v235
  v_mul_f32 v236, v7, v236
  v_mul_f32 v237, v7, v237
  v_mul_f32 v238, v7, v238
  v_mul_f32 v239, v7, v239
  v_mul_f32 v240, v6, v240
  v_mul_f32 v241, v6, v241
  v_mul_f32 v242, v6, v242
  v_mul_f32 v243, v6, v243
  v_mul_f32 v244, v7, v244
  v_mul_f32 v245, v7, v245
  v_mul_f32 v246, v7, v246
  v_mul_f32 v247, v7, v247
  v_mul_f32 v248, v6, v248
  v_mul_f32 v249, v6, v249
  v_mul_f32 v250, v6, v250
  v_mul_f32 v251, v6, v251
  v_mul_f32 v252, v7, v252
  v_mul_f32 v253, v7, v253
  v_mul_f32 v254, v7, v254
  v_mul_f32 v255, v7, v255
  s_nop 1
  s_branch L_back2
L_rare3:
  v_max3_f32 v1, v64, v65, v66
  v_max3_f32 v1, v1, v67, v68
  v_max3_f32 v1, v1, v69, v70
  v_max3_f32 v1, v1, v71, 0
  v_max3_f32 v4, v72, v73, v74
  v_max3_f32 v4, v4, v75, v76
  v_max3_f32 v4, v4, v77, v78
  v_max3_f32 v4, v4, v79, 0
  v_mov_b32 v6, v1
  v_mov_b32 v7, v4
  s_nop 0
  v_permlane16_swap_b32 v6, v1
  v_permlane16_swap_b32 v7, v4
  v_max_f32 v1, v1, v6
  v_max_f32 v4, v4, v7
  v_mov_b32 v6, v1
  v_mov_b32 v7, v4
  s_nop 0
  v_permlane32_swap_b32 v6, v1
  v_permlane32_swap_b32 v7, v4
  v_max_f32 v1, v1, v6
  v_max_f32 v4, v4, v7
  v_exp_f32 v6, -v1
  v_exp_f32 v7, -v4
  v_sub_f32 v24, v24, v1
  v_sub_f32 v25, v25, v1
  v_sub_f32 v26, v26, v1
  v_sub_f32 v27, v27, v1
  v_sub_f32 v64, v64, v1
  v_sub_f32 v65, v65, v1
  v_sub_f32 v66, v66, v1
  v_sub_f32 v67, v67, v1
  v_sub_f32 v68, v68, v1
  v_sub_f32 v69, v69, v1
  v_sub_f32 v70, v70, v1
  v_sub_f32 v71, v71, v1
  v_sub_f32 v48, v48, v1
  v_sub_f32 v49, v49, v1
  v_sub_f32 v50, v50, v1
  v_sub_f32 v51, v51, v1
  v_sub_f32 v52, v52, v1
  v_sub_f32 v53, v53, v1
  v_sub_f32 v54, v54, v1
  v_sub_f32 v55, v55, v1
  v_mul_f32 v22, v6, v22
  v_sub_f32 v28, v28, v4
  v_sub_f32 v29, v29, v4
  v_sub_f32 v30, v30, v4
  v_sub_f32 v31, v31, v4
  v_sub_f32 v72, v72, v4
  v_sub_f32 v73, v73, v4
  v_sub_f32 v74, v74, v4
  v_sub_f32 v75, v75, v4
  v_sub_f32 v76, v76, v4
  v_sub_f32 v77, v77, v4
  v_sub_f32 v78, v78, v4
  v_sub_f32 v79, v79, v4
  v_sub_f32 v56, v56, v4
  v_sub_f32 v57, v57, v4
  v_sub_f32 v58, v58, v4
  v_sub_f32 v59, v59, v4
  v_sub_f32 v60, v60, v4
  v_sub_f32 v61, v61, v4
  v_sub_f32 v62, v62, v4
  v_sub_f32 v63, v63, v4
  v_mul_f32 v23, v7, v23
  v_lshlrev_b32 v80, 16, v32
  v_and_b32 v81, 0xffff0000, v32
  v_mul_f32 v80, v6, v80
  v_mul_f32 v81, v6, v81
  v_cvt_pk_bf16_f32 v32, v80, v81
  v_lshlrev_b32 v80, 16, v33
  v_and_b32 v81, 0xffff0000, v33
  v_mul_f32 v80, v6, v80
  v_mul_f32 v81, v6, v81
  v_cvt_pk_bf16_f32 v33, v80, v81
  v_lshlrev_b32 v80, 16, v34
  v_and_b32 v81, 0xffff0000, v34
  v_mul_f32 v80, v6, v80
  v_mul_f32 v81, v6, v81
  v_cvt_pk_bf16_f32 v34, v80, v81
  v_lshlrev_b32 v80, 16, v35
  v_and_b32 v81, 0xffff0000, v35
  v_mul_f32 v80, v6, v80
  v_mul_f32 v81, v6, v81
  v_cvt_pk_bf16_f32 v35, v80, v81
  v_lshlrev_b32 v80, 16, v36
  v_and_b32 v81, 0xffff0000, v36
  v_mul_f32 v80, v7, v80
  v_mul_f32 v81, v7, v81
  v_cvt_pk_bf16_f32 v36, v80, v81
  v_lshlrev_b32 v80, 16, v37
  v_and_b32 v81, 0xffff0000, v37
  v_mul_f32 v80, v7, v80
  v_mul_f32 v81, v7, v81
  v_cvt_pk_bf16_f32 v37, v80, v81
  v_lshlrev_b32 v80, 16, v38
  v_and_b32 v81, 0xffff0000, v38
  v_mul_f32 v80, v7, v80
  v_mul_f32 v81, v7, v81
  v_cvt_pk_bf16_f32 v38, v80, v81
  v_lshlrev_b32 v80, 16, v39
  v_and_b32 v81, 0xffff0000, v39
  v_mul_f32 v80, v7, v80
  v_mul_f32 v81, v7, v81
  v_cvt_pk_bf16_f32 v39, v80, v81
  v_exp_f32 v80, v64
  v_exp_f32 v81, v65
  v_exp_f32 v82, v66
  v_add_f32 v8, v80, v81
  v_cvt_pk_bf16_f32 v40, v80, v81
  v_exp_f32 v83, v67
  v_add_f32 v8, v8, v82
  v_exp_f32 v84, v68
  v_add_f32 v8, v8, v83
  v_cvt_pk_bf16_f32 v41, v82, v83
  v_exp_f32 v85, v69
  v_add_f32 v8, v8, v84
  v_exp_f32 v86, v70
  v_add_f32 v8, v8, v85
  v_cvt_pk_bf16_f32 v42, v84, v85
  v_exp_f32 v87, v71
  v_add_f32 v8, v8, v86
  v_exp_f32 v88, v72
  v_add_f32 v8, v8, v87
  v_cvt_pk_bf16_f32 v43, v86, v87
  v_exp_f32 v89, v73
  v_exp_f32 v90, v74
  v_add_f32 v9, v88, v89
  v_cvt_pk_bf16_f32 v44, v88, v89
  v_exp_f32 v91, v75
  v_add_f32 v9, v9, v90
  v_exp_f32 v92, v76
  v_add_f32 v9, v9, v91
  v_cvt_pk_bf16_f32 v45, v90, v91
  v_exp_f32 v93, v77
  v_add_f32 v9, v9, v92
  v_exp_f32 v94, v78
  v_add_f32 v9, v9, v93
  v_cvt_pk_bf16_f32 v46, v92, v93
  v_exp_f32 v95, v79
  v_add_f32 v9, v9, v94
  v_add_f32 v9, v9, v95
  v_cvt_pk_bf16_f32 v47, v94, v95
  v_mul_f32 v128, v6, v128
  v_mul_f32 v129, v6, v129
  v_mul_f32 v130, v6, v130
  v_mul_f32 v131, v6, v131
  v_mul_f32 v132, v7, v132
  v_mul_f32 v133, v7, v133
  v_mul_f32 v134, v7, v134
  v_mul_f32 v135, v7, v135
  v_mul_f32 v136, v6, v136
  v_mul_f32 v137, v6, v137
  v_mul_f32 v138, v6, v138
  v_mul_f32 v139, v6, v139
  v_mul_f32 v140, v7, v140
  v_mul_f32 v141, v7, v141
  v_mul_f32 v142, v7, v142
  v_mul_f32 v143, v7, v143
  v_mul_f32 v144, v6, v144
  v_mul_f32 v145, v6, v145
  v_mul_f32 v146, v6, v146
  v_mul_f32 v147, v6, v147
  v_mul_f32 v148, v7, v148
  v_mul_f32 v149, v7, v149
  v_mul_f32 v150, v7, v150
  v_mul_f32 v151, v7, v151
  v_mul_f32 v152, v6, v152
  v_mul_f32 v153, v6, v153
  v_mul_f32 v154, v6, v154
  v_mul_f32 v155, v6, v155
  v_mul_f32 v156, v7, v156
  v_mul_f32 v157, v7, v157
  v_mul_f32 v158, v7, v158
  v_mul_f32 v159, v7, v159
  v_mul_f32 v160, v6, v160
  v_mul_f32 v161, v6, v161
  v_mul_f32 v162, v6, v162
  v_mul_f32 v163, v6, v163
  v_mul_f32 v164, v7, v164
  v_mul_f32 v165, v7, v165
  v_mul_f32 v166, v7, v166
  v_mul_f32 v167, v7, v167
  v_mul_f32 v168, v6, v168
  v_mul_f32 v169, v6, v169
  v_mul_f32 v170, v6, v170
  v_mul_f32 v171, v6, v171
  v_mul_f32 v172, v7, v172
  v_mul_f32 v173, v7, v173
  v_mul_f32 v174, v7, v174
  v_mul_f32 v175, v7, v175
  v_mul_f32 v176, v6, v176
  v_mul_f32 v177, v6, v177
  v_mul_f32 v178, v6, v178
  v_mul_f32 v179, v6, v179
  v_mul_f32 v180, v7, v180
  v_mul_f32 v181, v7, v181
  v_mul_f32 v182, v7, v182
  v_mul_f32 v183, v7, v183
  v_mul_f32 v184, v6, v184
  v_mul_f32 v185, v6, v185
  v_mul_f32 v186, v6, v186
  v_mul_f32 v187, v6, v187
  v_mul_f32 v188, v7, v188
  v_mul_f32 v189, v7, v189
  v_mul_f32 v190, v7, v190
  v_mul_f32 v191, v7, v191
  v_mul_f32 v192, v6, v192
  v_mul_f32 v193, v6, v193
  v_mul_f32 v194, v6, v194
  v_mul_f32 v195, v6, v195
  v_mul_f32 v196, v7, v196
  v_mul_f32 v197, v7, v197
  v_mul_f32 v198, v7, v198
  v_mul_f32 v199, v7, v199
  v_mul_f32 v200, v6, v200
  v_mul_f32 v201, v6, v201
  v_mul_f32 v202, v6, v202
  v_mul_f32 v203, v6, v203
  v_mul_f32 v204, v7, v204
  v_mul_f32 v205, v7, v205
  v_mul_f32 v206, v7, v206
  v_mul_f32 v207, v7, v207
  v_mul_f32 v208, v6, v208
  v_mul_f32 v209, v6, v209
  v_mul_f32 v210, v6, v210
  v_mul_f32 v211, v6, v211
  v_mul_f32 v212, v7, v212
  v_mul_f32 v213, v7, v213
  v_mul_f32 v214, v7, v214
  v_mul_f32 v215, v7, v215
  v_mul_f32 v216, v6, v216
  v_mul_f32 v217, v6, v217
  v_mul_f32 v218, v6, v218
  v_mul_f32 v219, v6, v219
  v_mul_f32 v220, v7, v220
  v_mul_f32 v221, v7, v221
  v_mul_f32 v222, v7, v222
  v_mul_f32 v223, v7, v223
  v_mul_f32 v224, v6, v224
  v_mul_f32 v225, v6, v225
  v_mul_f32 v226, v6, v226
  v_mul_f32 v227, v6, v227
  v_mul_f32 v228, v7, v228
  v_mul_f32 v229, v7, v229
  v_mul_f32 v230, v7, v230
  v_mul_f32 v231, v7, v231
  v_mul_f32 v232, v6, v232
  v_mul_f32 v233, v6, v233
  v_mul_f32 v234, v6, v234
  v_mul_f32 v235, v6, v235
  v_mul_f32 v236, v7, v236
  v_mul_f32 v237, v7, v237
  v_mul_f32 v238, v7, v238
  v_mul_f32 v239, v7, v239
  v_mul_f32 v240, v6, v240
  v_mul_f32 v241, v6, v241
  v_mul_f32 v242, v6, v242
  v_mul_f32 v243, v6, v243
  v_mul_f32 v244, v7, v244
  v_mul_f32 v245, v7, v245
  v_mul_f32 v246, v7, v246
  v_mul_f32 v247, v7, v247
  v_mul_f32 v248, v6, v248
  v_mul_f32 v249, v6, v249
  v_mul_f32 v250, v6, v250
  v_mul_f32 v251, v6, v251
  v_mul_f32 v252, v7, v252
  v_mul_f32 v253, v7, v253
  v_mul_f32 v254, v7, v254
  v_mul_f32 v255, v7, v255
  s_nop 1
  s_branch L_back3
L_rare4:
  v_max3_f32 v1, v48, v49, v50
  v_max3_f32 v1, v1, v51, v52
  v_max3_f32 v1, v1, v53, v54
  v_max3_f32 v1, v1, v55, 0
  v_max3_f32 v4, v56, v57, v58
  v_max3_f32 v4, v4, v59, v60
  v_max3_f32 v4, v4, v61, v62
  v_max3_f32 v4, v4, v63, 0
  v_mov_b32 v6, v1
  v_mov_b32 v7, v4
  s_nop 0
  v_permlane16_swap_b32 v6, v1
  v_permlane16_swap_b32 v7, v4
  v_max_f32 v1, v1, v6
  v_max_f32 v4, v4, v7
  v_mov_b32 v6, v1
  v_mov_b32 v7, v4
  s_nop 0
  v_permlane32_swap_b32 v6, v1
  v_permlane32_swap_b32 v7, v4
  v_max_f32 v1, v1, v6
  v_max_f32 v4, v4, v7
  v_exp_f32 v6, -v1
  v_exp_f32 v7, -v4
  v_sub_f32 v24, v24, v1
  v_sub_f32 v25, v25, v1
  v_sub_f32 v26, v26, v1
  v_sub_f32 v27, v27, v1
  v_sub_f32 v48, v48, v1
  v_sub_f32 v49, v49, v1
  v_sub_f32 v50, v50, v1
  v_sub_f32 v51, v51, v1
  v_sub_f32 v52, v52, v1
  v_sub_f32 v53, v53, v1
  v_sub_f32 v54, v54, v1
  v_sub_f32 v55, v55, v1
  v_sub_f32 v64, v64, v1
  v_sub_f32 v65, v65, v1
  v_sub_f32 v66, v66, v1
  v_sub_f32 v67, v67, v1
  v_sub_f32 v68, v68, v1
  v_sub_f32 v69, v69, v1
  v_sub_f32 v70, v70, v1
  v_sub_f32 v71, v71, v1
  v_mul_f32 v22, v6, v22
  v_sub_f32 v28, v28, v4
  v_sub_f32 v29, v29, v4
  v_sub_f32 v30, v30, v4
  v_sub_f32 v31, v31, v4
  v_sub_f32 v56, v56, v4
  v_sub_f32 v57, v57, v4
  v_sub_f32 v58, v58, v4
  v_sub_f32 v59, v59, v4
  v_sub_f32 v60, v60, v4
  v_sub_f32 v61, v61, v4
  v_sub_f32 v62, v62, v4
  v_sub_f32 v63, v63, v4
  v_sub_f32 v72, v72, v4
  v_sub_f32 v73, v73, v4
  v_sub_f32 v74, v74, v4
  v_sub_f32 v75, v75, v4
  v_sub_f32 v76, v76, v4
  v_sub_f32 v77, v77, v4
  v_sub_f32 v78, v78, v4
  v_sub_f32 v79, v79, v4
  v_mul_f32 v23, v7, v23
  v_lshlrev_b32 v80, 16, v32
  v_and_b32 v81, 0xffff0000, v32
  v_mul_f32 v80, v6, v80
  v_mul_f32 v81, v6, v81
  v_cvt_pk_bf16_f32 v32, v80, v81
  v_lshlrev_b32 v80, 16, v33
  v_and_b32 v81, 0xffff0000, v33
  v_mul_f32 v80, v6, v80
  v_mul_f32 v81, v6, v81
  v_cvt_pk_bf16_f32 v33, v80, v81
  v_lshlrev_b32 v80, 16, v34
  v_and_b32 v81, 0xffff0000, v34
  v_mul_f32 v80, v6, v80
  v_mul_f32 v81, v6, v81
  v_cvt_pk_bf16_f32 v34, v80, v81
  v_lshlrev_b32 v80, 16, v35
  v_and_b32 v81, 0xffff0000, v35
  v_mul_f32 v80, v6, v80
  v_mul_f32 v81, v6, v81
  v_cvt_pk_bf16_f32 v35, v80, v81
  v_lshlrev_b32 v80, 16, v36
  v_and_b32 v81, 0xffff0000, v36
  v_mul_f32 v80, v7, v80
  v_mul_f32 v81, v7, v81
  v_cvt_pk_bf16_f32 v36, v80, v81
  v_lshlrev_b32 v80, 16, v37
  v_and_b32 v81, 0xffff0000, v37
  v_mul_f32 v80, v7, v80
  v_mul_f32 v81, v7, v81
  v_cvt_pk_bf16_f32 v37, v80, v81
  v_lshlrev_b32 v80, 16, v38
  v_and_b32 v81, 0xffff0000, v38
  v_mul_f32 v80, v7, v80
  v_mul_f32 v81, v7, v81
  v_cvt_pk_bf16_f32 v38, v80, v81
  v_lshlrev_b32 v80, 16, v39
  v_and_b32 v81, 0xffff0000, v39
  v_mul_f32 v80, v7, v80
  v_mul_f32 v81, v7, v81
  v_cvt_pk_bf16_f32 v39, v80, v81
  v_lshlrev_b32 v80, 16, v40
  v_and_b32 v81, 0xffff0000, v40
  v_mul_f32 v80, v6, v80
  v_mul_f32 v81, v6, v81
  v_cvt_pk_bf16_f32 v40, v80, v81
  v_lshlrev_b32 v80, 16, v41
  v_and_b32 v81, 0xffff0000, v41
  v_mul_f32 v80, v6, v80
  v_mul_f32 v81, v6, v81
  v_cvt_pk_bf16_f32 v41, v80, v81
  v_lshlrev_b32 v80, 16, v42
  v_and_b32 v81, 0xffff0000, v42
  v_mul_f32 v80, v6, v80
  v_mul_f32 v81, v6, v81
  v_cvt_pk_bf16_f32 v42, v80, v81
  v_lshlrev_b32 v80, 16, v43
  v_and_b32 v81, 0xffff0000, v43
  v_mul_f32 v80, v6, v80
  v_mul_f32 v81, v6, v81
  v_cvt_pk_bf16_f32 v43, v80, v81
  v_lshlrev_b32 v80, 16, v44
  v_and_b32 v81, 0xffff0000, v44
  v_mul_f32 v80, v7, v80
  v_mul_f32 v81, v7, v81
  v_cvt_pk_bf16_f32 v44, v80, v81
  v_lshlrev_b32 v80, 16, v45
  v_and_b32 v81, 0xffff0000, v45
  v_mul_f32 v80, v7, v80
  v_mul_f32 v81, v7, v81
  v_cvt_pk_bf16_f32 v45, v80, v81
  v_lshlrev_b32 v80, 16, v46
  v_and_b32 v81, 0xffff0000, v46
  v_mul_f32 v80, v7, v80
  v_mul_f32 v81, v7, v81
  v_cvt_pk_bf16_f32 v46, v80, v81
  v_lshlrev_b32 v80, 16, v47
  v_and_b32 v81, 0xffff0000, v47
  v_mul_f32 v80, v7, v80
  v_mul_f32 v81, v7, v81
  v_cvt_pk_bf16_f32 v47, v80, v81
  v_exp_f32 v80, v48
  v_exp_f32 v81, v49
  v_exp_f32 v82, v50
  v_add_f32 v8, v80, v81
  v_cvt_pk_bf16_f32 v112, v80, v81
  v_exp_f32 v83, v51
  v_add_f32 v8, v8, v82
  v_exp_f32 v84, v52
  v_add_f32 v8, v8, v83
  v_cvt_pk_bf16_f32 v113, v82, v83
  v_exp_f32 v85, v53
  v_add_f32 v8, v8, v84
  v_exp_f32 v86, v54
  v_add_f32 v8, v8, v85
  v_cvt_pk_bf16_f32 v114, v84, v85
  v_exp_f32 v87, v55
  v_add_f32 v8, v8, v86
  v_exp_f32 v88, v56
  v_add_f32 v8, v8, v87
  v_cvt_pk_bf16_f32 v115, v86, v87
  v_exp_f32 v89, v57
  v_exp_f32 v90, v58
  v_add_f32 v9, v88, v89
  v_cvt_pk_bf16_f32 v116, v88, v89
  v_exp_f32 v91, v59
  v_add_f32 v9, v9, v90
  v_exp_f32 v92, v60
  v_add_f32 v9, v9, v91
  v_cvt_pk_bf16_f32 v117, v90, v91
  v_exp_f32 v93, v61
  v_add_f32 v9, v9, v92
  v_exp_f32 v94, v62
  v_add_f32 v9, v9, v93
  v_cvt_pk_bf16_f32 v118, v92, v93
  v_exp_f32 v95, v63
  v_add_f32 v9, v9, v94
  v_add_f32 v9, v9, v95
  v_cvt_pk_bf16_f32 v119, v94, v95
  v_mul_f32 v128, v6, v128
  v_mul_f32 v129, v6, v129
  v_mul_f32 v130, v6, v130
  v_mul_f32 v131, v6, v131
  v_mul_f32 v132, v7, v132
  v_mul_f32 v133, v7, v133
  v_mul_f32 v134, v7, v134
  v_mul_f32 v135, v7, v135
  v_mul_f32 v136, v6, v136
  v_mul_f32 v137, v6, v137
  v_mul_f32 v138, v6, v138
  v_mul_f32 v139, v6, v139
  v_mul_f32 v140, v7, v140
  v_mul_f32 v141, v7, v141
  v_mul_f32 v142, v7, v142
  v_mul_f32 v143, v7, v143
  v_mul_f32 v144, v6, v144
  v_mul_f32 v145, v6, v145
  v_mul_f32 v146, v6, v146
  v_mul_f32 v147, v6, v147
  v_mul_f32 v148, v7, v148
  v_mul_f32 v149, v7, v149
  v_mul_f32 v150, v7, v150
  v_mul_f32 v151, v7, v151
  v_mul_f32 v152, v6, v152
  v_mul_f32 v153, v6, v153
  v_mul_f32 v154, v6, v154
  v_mul_f32 v155, v6, v155
  v_mul_f32 v156, v7, v156
  v_mul_f32 v157, v7, v157
  v_mul_f32 v158, v7, v158
  v_mul_f32 v159, v7, v159
  v_mul_f32 v160, v6, v160
  v_mul_f32 v161, v6, v161
  v_mul_f32 v162, v6, v162
  v_mul_f32 v163, v6, v163
  v_mul_f32 v164, v7, v164
  v_mul_f32 v165, v7, v165
  v_mul_f32 v166, v7, v166
  v_mul_f32 v167, v7, v167
  v_mul_f32 v168, v6, v168
  v_mul_f32 v169, v6, v169
  v_mul_f32 v170, v6, v170
  v_mul_f32 v171, v6, v171
  v_mul_f32 v172, v7, v172
  v_mul_f32 v173, v7, v173
  v_mul_f32 v174, v7, v174
  v_mul_f32 v175, v7, v175
  v_mul_f32 v176, v6, v176
  v_mul_f32 v177, v6, v177
  v_mul_f32 v178, v6, v178
  v_mul_f32 v179, v6, v179
  v_mul_f32 v180, v7, v180
  v_mul_f32 v181, v7, v181
  v_mul_f32 v182, v7, v182
  v_mul_f32 v183, v7, v183
  v_mul_f32 v184, v6, v184
  v_mul_f32 v185, v6, v185
  v_mul_f32 v186, v6, v186
  v_mul_f32 v187, v6, v187
  v_mul_f32 v188, v7, v188
  v_mul_f32 v189, v7, v189
  v_mul_f32 v190, v7, v190
  v_mul_f32 v191, v7, v191
  v_mul_f32 v192, v6, v192
  v_mul_f32 v193, v6, v193
  v_mul_f32 v194, v6, v194
  v_mul_f32 v195, v6, v195
  v_mul_f32 v196, v7, v196
  v_mul_f32 v197, v7, v197
  v_mul_f32 v198, v7, v198
  v_mul_f32 v199, v7, v199
  v_mul_f32 v200, v6, v200
  v_mul_f32 v201, v6, v201
  v_mul_f32 v202, v6, v202
  v_mul_f32 v203, v6, v203
  v_mul_f32 v204, v7, v204
  v_mul_f32 v205, v7, v205
  v_mul_f32 v206, v7, v206
  v_mul_f32 v207, v7, v207
  v_mul_f32 v208, v6, v208
  v_mul_f32 v209, v6, v209
  v_mul_f32 v210, v6, v210
  v_mul_f32 v211, v6, v211
  v_mul_f32 v212, v7, v212
  v_mul_f32 v213, v7, v213
  v_mul_f32 v214, v7, v214
  v_mul_f32 v215, v7, v215
  v_mul_f32 v216, v6, v216
  v_mul_f32 v217, v6, v217
  v_mul_f32 v218, v6, v218
  v_mul_f32 v219, v6, v219
  v_mul_f32 v220, v7, v220
  v_mul_f32 v221, v7, v221
  v_mul_f32 v222, v7, v222
  v_mul_f32 v223, v7, v223
  v_mul_f32 v224, v6, v224
  v_mul_f32 v225, v6, v225
  v_mul_f32 v226, v6, v226
  v_mul_f32 v227, v6, v227
  v_mul_f32 v228, v7, v228
  v_mul_f32 v229, v7, v229
  v_mul_f32 v230, v7, v230
  v_mul_f32 v231, v7, v231
  v_mul_f32 v232, v6, v232
  v_mul_f32 v233, v6, v233
  v_mul_f32 v234, v6, v234
  v_mul_f32 v235, v6, v235
  v_mul_f32 v236, v7, v236
  v_mul_f32 v237, v7, v237
  v_mul_f32 v238, v7, v238
  v_mul_f32 v239, v7, v239
  v_mul_f32 v240, v6, v240
  v_mul_f32 v241, v6, v241
  v_mul_f32 v242, v6, v242
  v_mul_f32 v243, v6, v243
  v_mul_f32 v244, v7, v244
  v_mul_f32 v245, v7, v245
  v_mul_f32 v246, v7, v246
  v_mul_f32 v247, v7, v247
  v_mul_f32 v248, v6, v248
  v_mul_f32 v249, v6, v249
  v_mul_f32 v250, v6, v250
  v_mul_f32 v251, v6, v251
  v_mul_f32 v252, v7, v252
  v_mul_f32 v253, v7, v253
  v_mul_f32 v254, v7, v254
  v_mul_f32 v255, v7, v255
  s_nop 1
  s_branch L_back4
L_rare5:
  v_max3_f32 v1, v64, v65, v66
  v_max3_f32 v1, v1, v67, v68
  v_max3_f32 v1, v1, v69, v70
  v_max3_f32 v1, v1, v71, 0
  v_max3_f32 v4, v72, v73, v74
  v_max3_f32 v4, v4, v75, v76
  v_max3_f32 v4, v4, v77, v78
  v_max3_f32 v4, v4, v79, 0
  v_mov_b32 v6, v1
  v_mov_b32 v7, v4
  s_nop 0
  v_permlane16_swap_b32 v6, v1
  v_permlane16_swap_b32 v7, v4
  v_max_f32 v1, v1, v6
  v_max_f32 v4, v4, v7
  v_mov_b32 v6, v1
  v_mov_b32 v7, v4
  s_nop 0
  v_permlane32_swap_b32 v6, v1
  v_permlane32_swap_b32 v7, v4
  v_max_f32 v1, v1, v6
  v_max_f32 v4, v4, v7
  v_exp_f32 v6, -v1
  v_exp_f32 v7, -v4
  v_sub_f32 v24, v24, v1
  v_sub_f32 v25, v25, v1
  v_sub_f32 v26, v26, v1
  v_sub_f32 v27, v27, v1
  v_sub_f32 v64, v64, v1
  v_sub_f32 v65, v65, v1
  v_sub_f32 v66, v66, v1
  v_sub_f32 v67, v67, v1
  v_sub_f32 v68, v68, v1
  v_sub_f32 v69, v69, v1
  v_sub_f32 v70, v70, v1
  v_sub_f32 v71, v71, v1
  v_sub_f32 v48, v48, v1
  v_sub_f32 v49, v49, v1
  v_sub_f32 v50, v50, v1
  v_sub_f32 v51, v51, v1
  v_sub_f32 v52, v52, v1
  v_sub_f32 v53, v53, v1
  v_sub_f32 v54, v54, v1
  v_sub_f32 v55, v55, v1
  v_mul_f32 v22, v6, v22
  v_sub_f32 v28, v28, v4
  v_sub_f32 v29, v29, v4
  v_sub_f32 v30, v30, v4
  v_sub_f32 v31, v31, v4
  v_sub_f32 v72, v72, v4
  v_sub_f32 v73, v73, v4
  v_sub_f32 v74, v74, v4
  v_sub_f32 v75, v75, v4
  v_sub_f32 v76, v76, v4
  v_sub_f32 v77, v77, v4
  v_sub_f32 v78, v78, v4
  v_sub_f32 v79, v79, v4
  v_sub_f32 v56, v56, v4
  v_sub_f32 v57, v57, v4
  v_sub_f32 v58, v58, v4
  v_sub_f32 v59, v59, v4
  v_sub_f32 v60, v60, v4
  v_sub_f32 v61, v61, v4
  v_sub_f32 v62, v62, v4
  v_sub_f32 v63, v63, v4
  v_mul_f32 v23, v7, v23
  v_exp_f32 v80, v64
  v_exp_f32 v81, v65
  v_exp_f32 v82, v66
  v_add_f32 v8, v80, v81
  v_cvt_pk_bf16_f32 v40, v80, v81
  v_exp_f32 v83, v67
  v_add_f32 v8, v8, v82
  v_exp_f32 v84, v68
  v_add_f32 v8, v8, v83
  v_cvt_pk_bf16_f32 v41, v82, v83
  v_exp_f32 v85, v69
  v_add_f32 v8, v8, v84
  v_exp_f32 v86, v70
  v_add_f32 v8, v8, v85
  v_cvt_pk_bf16_f32 v42, v84, v85
  v_exp_f32 v87, v71
  v_add_f32 v8, v8, v86
  v_exp_f32 v88, v72
  v_add_f32 v8, v8, v87
  v_cvt_pk_bf16_f32 v43, v86, v87
  v_exp_f32 v89, v73
  v_exp_f32 v90, v74
  v_add_f32 v9, v88, v89
  v_cvt_pk_bf16_f32 v44, v88, v89
  v_exp_f32 v91, v75
  v_add_f32 v9, v9, v90
  v_exp_f32 v92, v76
  v_add_f32 v9, v9, v91
  v_cvt_pk_bf16_f32 v45, v90, v91
  v_exp_f32 v93, v77
  v_add_f32 v9, v9, v92
  v_exp_f32 v94, v78
  v_add_f32 v9, v9, v93
  v_cvt_pk_bf16_f32 v46, v92, v93
  v_exp_f32 v95, v79
  v_add_f32 v9, v9, v94
  v_add_f32 v9, v9, v95
  v_cvt_pk_bf16_f32 v47, v94, v95
  v_mul_f32 v128, v6, v128
  v_mul_f32 v129, v6, v129
  v_mul_f32 v130, v6, v130
  v_mul_f32 v131, v6, v131
  v_mul_f32 v132, v7, v132
  v_mul_f32 v133, v7, v133
  v_mul_f32 v134, v7, v134
  v_mul_f32 v135, v7, v135
  v_mul_f32 v136, v6, v136
  v_mul_f32 v137, v6, v137
  v_mul_f32 v138, v6, v138
  v_mul_f32 v139, v6, v139
  v_mul_f32 v140, v7, v140
  v_mul_f32 v141, v7, v141
  v_mul_f32 v142, v7, v142
  v_mul_f32 v143, v7, v143
  v_mul_f32 v144, v6, v144
  v_mul_f32 v145, v6, v145
  v_mul_f32 v146, v6, v146
  v_mul_f32 v147, v6, v147
  v_mul_f32 v148, v7, v148
  v_mul_f32 v149, v7, v149
  v_mul_f32 v150, v7, v150
  v_mul_f32 v151, v7, v151
  v_mul_f32 v152, v6, v152
  v_mul_f32 v153, v6, v153
  v_mul_f32 v154, v6, v154
  v_mul_f32 v155, v6, v155
  v_mul_f32 v156, v7, v156
  v_mul_f32 v157, v7, v157
  v_mul_f32 v158, v7, v158
  v_mul_f32 v159, v7, v159
  v_mul_f32 v160, v6, v160
  v_mul_f32 v161, v6, v161
  v_mul_f32 v162, v6, v162
  v_mul_f32 v163, v6, v163
  v_mul_f32 v164, v7, v164
  v_mul_f32 v165, v7, v165
  v_mul_f32 v166, v7, v166
  v_mul_f32 v167, v7, v167
  v_mul_f32 v168, v6, v168
  v_mul_f32 v169, v6, v169
  v_mul_f32 v170, v6, v170
  v_mul_f32 v171, v6, v171
  v_mul_f32 v172, v7, v172
  v_mul_f32 v173, v7, v173
  v_mul_f32 v174, v7, v174
  v_mul_f32 v175, v7, v175
  v_mul_f32 v176, v6, v176
  v_mul_f32 v177, v6, v177
  v_mul_f32 v178, v6, v178
  v_mul_f32 v179, v6, v179
  v_mul_f32 v180, v7, v180
  v_mul_f32 v181, v7, v181
  v_mul_f32 v182, v7, v182
  v_mul_f32 v183, v7, v183
  v_mul_f32 v184, v6, v184
  v_mul_f32 v185, v6, v185
  v_mul_f32 v186, v6, v186
  v_mul_f32 v187, v6, v187
  v_mul_f32 v188, v7, v188
  v_mul_f32 v189, v7, v189
  v_mul_f32 v190, v7, v190
  v_mul_f32 v191, v7, v191
  v_mul_f32 v192, v6, v192
  v_mul_f32 v193, v6, v193
  v_mul_f32 v194, v6, v194
  v_mul_f32 v195, v6, v195
  v_mul_f32 v196, v7, v196
  v_mul_f32 v197, v7, v197
  v_mul_f32 v198, v7, v198
  v_mul_f32 v199, v7, v199
  v_mul_f32 v200, v6, v200
  v_mul_f32 v201, v6, v201
  v_mul_f32 v202, v6, v202
  v_mul_f32 v203, v6, v203
  v_mul_f32 v204, v7, v204
  v_mul_f32 v205, v7, v205
  v_mul_f32 v206, v7, v206
  v_mul_f32 v207, v7, v207
  v_mul_f32 v208, v6, v208
  v_mul_f32 v209, v6, v209
  v_mul_f32 v210, v6, v210
  v_mul_f32 v211, v6, v211
  v_mul_f32 v212, v7, v212
  v_mul_f32 v213, v7, v213
  v_mul_f32 v214, v7, v214
  v_mul_f32 v215, v7, v215
  v_mul_f32 v216, v6, v216
  v_mul_f32 v217, v6, v217
  v_mul_f32 v218, v6, v218
  v_mul_f32 v219, v6, v219
  v_mul_f32 v220, v7, v220
  v_mul_f32 v221, v7, v221
  v_mul_f32 v222, v7, v222
  v_mul_f32 v223, v7, v223
  v_mul_f32 v224, v6, v224
  v_mul_f32 v225, v6, v225
  v_mul_f32 v226, v6, v226
  v_mul_f32 v227, v6, v227
  v_mul_f32 v228, v7, v228
  v_mul_f32 v229, v7, v229
  v_mul_f32 v230, v7, v230
  v_mul_f32 v231, v7, v231
  v_mul_f32 v232, v6, v232
  v_mul_f32 v233, v6, v233
  v_mul_f32 v234, v6, v234
  v_mul_f32 v235, v6, v235
  v_mul_f32 v236, v7, v236
  v_mul_f32 v237, v7, v237
  v_mul_f32 v238, v7, v238
  v_mul_f32 v239, v7, v239
  v_mul_f32 v240, v6, v240
  v_mul_f32 v241, v6, v241
  v_mul_f32 v242, v6, v242
  v_mul_f32 v243, v6, v243
  v_mul_f32 v244, v7, v244
  v_mul_f32 v245, v7, v245
  v_mul_f32 v246, v7, v246
  v_mul_f32 v247, v7, v247
  v_mul_f32 v248, v6, v248
  v_mul_f32 v249, v6, v249
  v_mul_f32 v250, v6, v250
  v_mul_f32 v251, v6, v251
  v_mul_f32 v252, v7, v252
  v_mul_f32 v253, v7, v253
  v_mul_f32 v254, v7, v254
  v_mul_f32 v255, v7, v255
  s_nop 1
  s_branch L_back5
L_rare6:
  v_max3_f32 v1, v48, v49, v50
  v_max3_f32 v1, v1, v51, v52
  v_max3_f32 v1, v1, v53, v54
  v_max3_f32 v1, v1, v55, 0
  v_max3_f32 v4, v56, v57, v58
  v_max3_f32 v4, v4, v59, v60
  v_max3_f32 v4, v4, v61, v62
  v_max3_f32 v4, v4, v63, 0
  v_mov_b32 v6, v1
  v_mov_b32 v7, v4
  s_nop 0
  v_permlane16_swap_b32 v6, v1
  v_permlane16_swap_b32 v7, v4
  v_max_f32 v1, v1, v6
  v_max_f32 v4, v4, v7
  v_mov_b32 v6, v1
  v_mov_b32 v7, v4
  s_nop 0
  v_permlane32_swap_b32 v6, v1
  v_permlane32_swap_b32 v7, v4
  v_max_f32 v1, v1, v6
  v_max_f32 v4, v4, v7
  v_exp_f32 v6, -v1
  v_exp_f32 v7, -v4
  v_sub_f32 v24, v24, v1
  v_sub_f32 v25, v25, v1
  v_sub_f32 v26, v26, v1
  v_sub_f32 v27, v27, v1
  v_sub_f32 v48, v48, v1
  v_sub_f32 v49, v49, v1
  v_sub_f32 v50, v50, v1
  v_sub_f32 v51, v51, v1
  v_sub_f32 v52, v52, v1
  v_sub_f32 v53, v53, v1
  v_sub_f32 v54, v54, v1
  v_sub_f32 v55, v55, v1
  v_sub_f32 v64, v64, v1
  v_sub_f32 v65, v65, v1
  v_sub_f32 v66, v66, v1
  v_sub_f32 v67, v67, v1
  v_sub_f32 v68, v68, v1
  v_sub_f32 v69, v69, v1
  v_sub_f32 v70, v70, v1
  v_sub_f32 v71, v71, v1
  v_mul_f32 v22, v6, v22
  v_sub_f32 v28, v28, v4
  v_sub_f32 v29, v29, v4
  v_sub_f32 v30, v30, v4
  v_sub_f32 v31, v31, v4
  v_sub_f32 v56, v56, v4
  v_sub_f32 v57, v57, v4
  v_sub_f32 v58, v58, v4
  v_sub_f32 v59, v59, v4
  v_sub_f32 v60, v60, v4
  v_sub_f32 v61, v61, v4
  v_sub_f32 v62, v62, v4
  v_sub_f32 v63, v63, v4
  v_sub_f32 v72, v72, v4
  v_sub_f32 v73, v73, v4
  v_sub_f32 v74, v74, v4
  v_sub_f32 v75, v75, v4
  v_sub_f32 v76, v76, v4
  v_sub_f32 v77, v77, v4
  v_sub_f32 v78, v78, v4
  v_sub_f32 v79, v79, v4
  v_mul_f32 v23, v7, v23
  v_exp_f32 v80, v48
  v_exp_f32 v81, v49
  v_exp_f32 v82, v50
  v_add_f32 v8, v80, v81
  v_cvt_pk_bf16_f32 v32, v80, v81
  v_exp_f32 v83, v51
  v_add_f32 v8, v8, v82
  v_exp_f32 v84, v52
  v_add_f32 v8, v8, v83
  v_cvt_pk_bf16_f32 v33, v82, v83
  v_exp_f32 v85, v53
  v_add_f32 v8, v8, v84
  v_exp_f32 v86, v54
  v_add_f32 v8, v8, v85
  v_cvt_pk_bf16_f32 v34, v84, v85
  v_exp_f32 v87, v55
  v_add_f32 v8, v8, v86
  v_exp_f32 v88, v56
  v_add_f32 v8, v8, v87
  v_cvt_pk_bf16_f32 v35, v86, v87
  v_exp_f32 v89, v57
  v_exp_f32 v90, v58
  v_add_f32 v9, v88, v89
  v_cvt_pk_bf16_f32 v36, v88, v89
  v_exp_f32 v91, v59
  v_add_f32 v9, v9, v90
  v_exp_f32 v92, v60
  v_add_f32 v9, v9, v91
  v_cvt_pk_bf16_f32 v37, v90, v91
  v_exp_f32 v93, v61
  v_add_f32 v9, v9, v92
  v_exp_f32 v94, v62
  v_add_f32 v9, v9, v93
  v_cvt_pk_bf16_f32 v38, v92, v93
  v_exp_f32 v95, v63
  v_add_f32 v9, v9, v94
  v_add_f32 v9, v9, v95
  v_cvt_pk_bf16_f32 v39, v94, v95
  v_mul_f32 v128, v6, v128
  v_mul_f32 v129, v6, v129
  v_mul_f32 v130, v6, v130
  v_mul_f32 v131, v6, v131
  v_mul_f32 v132, v7, v132
  v_mul_f32 v133, v7, v133
  v_mul_f32 v134, v7, v134
  v_mul_f32 v135, v7, v135
  v_mul_f32 v136, v6, v136
  v_mul_f32 v137, v6, v137
  v_mul_f32 v138, v6, v138
  v_mul_f32 v139, v6, v139
  v_mul_f32 v140, v7, v140
  v_mul_f32 v141, v7, v141
  v_mul_f32 v142, v7, v142
  v_mul_f32 v143, v7, v143
  v_mul_f32 v144, v6, v144
  v_mul_f32 v145, v6, v145
  v_mul_f32 v146, v6, v146
  v_mul_f32 v147, v6, v147
  v_mul_f32 v148, v7, v148
  v_mul_f32 v149, v7, v149
  v_mul_f32 v150, v7, v150
  v_mul_f32 v151, v7, v151
  v_mul_f32 v152, v6, v152
  v_mul_f32 v153, v6, v153
  v_mul_f32 v154, v6, v154
  v_mul_f32 v155, v6, v155
  v_mul_f32 v156, v7, v156
  v_mul_f32 v157, v7, v157
  v_mul_f32 v158, v7, v158
  v_mul_f32 v159, v7, v159
  v_mul_f32 v160, v6, v160
  v_mul_f32 v161, v6, v161
  v_mul_f32 v162, v6, v162
  v_mul_f32 v163, v6, v163
  v_mul_f32 v164, v7, v164
  v_mul_f32 v165, v7, v165
  v_mul_f32 v166, v7, v166
  v_mul_f32 v167, v7, v167
  v_mul_f32 v168, v6, v168
  v_mul_f32 v169, v6, v169
  v_mul_f32 v170, v6, v170
  v_mul_f32 v171, v6, v171
  v_mul_f32 v172, v7, v172
  v_mul_f32 v173, v7, v173
  v_mul_f32 v174, v7, v174
  v_mul_f32 v175, v7, v175
  v_mul_f32 v176, v6, v176
  v_mul_f32 v177, v6, v177
  v_mul_f32 v178, v6, v178
  v_mul_f32 v179, v6, v179
  v_mul_f32 v180, v7, v180
  v_mul_f32 v181, v7, v181
  v_mul_f32 v182, v7, v182
  v_mul_f32 v183, v7, v183
  v_mul_f32 v184, v6, v184
  v_mul_f32 v185, v6, v185
  v_mul_f32 v186, v6, v186
  v_mul_f32 v187, v6, v187
  v_mul_f32 v188, v7, v188
  v_mul_f32 v189, v7, v189
  v_mul_f32 v190, v7, v190
  v_mul_f32 v191, v7, v191
  v_mul_f32 v192, v6, v192
  v_mul_f32 v193, v6, v193
  v_mul_f32 v194, v6, v194
  v_mul_f32 v195, v6, v195
  v_mul_f32 v196, v7, v196
  v_mul_f32 v197, v7, v197
  v_mul_f32 v198, v7, v198
  v_mul_f32 v199, v7, v199
  v_mul_f32 v200, v6, v200
  v_mul_f32 v201, v6, v201
  v_mul_f32 v202, v6, v202
  v_mul_f32 v203, v6, v203
  v_mul_f32 v204, v7, v204
  v_mul_f32 v205, v7, v205
  v_mul_f32 v206, v7, v206
  v_mul_f32 v207, v7, v207
  v_mul_f32 v208, v6, v208
  v_mul_f32 v209, v6, v209
  v_mul_f32 v210, v6, v210
  v_mul_f32 v211, v6, v211
  v_mul_f32 v212, v7, v212
  v_mul_f32 v213, v7, v213
  v_mul_f32 v214, v7, v214
  v_mul_f32 v215, v7, v215
  v_mul_f32 v216, v6, v216
  v_mul_f32 v217, v6, v217
  v_mul_f32 v218, v6, v218
  v_mul_f32 v219, v6, v219
  v_mul_f32 v220, v7, v220
  v_mul_f32 v221, v7, v221
  v_mul_f32 v222, v7, v222
  v_mul_f32 v223, v7, v223
  v_mul_f32 v224, v6, v224
  v_mul_f32 v225, v6, v225
  v_mul_f32 v226, v6, v226
  v_mul_f32 v227, v6, v227
  v_mul_f32 v228, v7, v228
  v_mul_f32 v229, v7, v229
  v_mul_f32 v230, v7, v230
  v_mul_f32 v231, v7, v231
  v_mul_f32 v232, v6, v232
  v_mul_f32 v233, v6, v233
  v_mul_f32 v234, v6, v234
  v_mul_f32 v235, v6, v235
  v_mul_f32 v236, v7, v236
  v_mul_f32 v237, v7, v237
  v_mul_f32 v238, v7, v238
  v_mul_f32 v239, v7, v239
  v_mul_f32 v240, v6, v240
  v_mul_f32 v241, v6, v241
  v_mul_f32 v242, v6, v242
  v_mul_f32 v243, v6, v243
  v_mul_f32 v244, v7, v244
  v_mul_f32 v245, v7, v245
  v_mul_f32 v246, v7, v246
  v_mul_f32 v247, v7, v247
  v_mul_f32 v248, v6, v248
  v_mul_f32 v249, v6, v249
  v_mul_f32 v250, v6, v250
  v_mul_f32 v251, v6, v251
  v_mul_f32 v252, v7, v252
  v_mul_f32 v253, v7, v253
  v_mul_f32 v254, v7, v254
  v_mul_f32 v255, v7, v255
  s_nop 1
  s_branch L_back6
L_rare7:
  v_max3_f32 v1, v64, v65, v66
  v_max3_f32 v1, v1, v67, v68
  v_max3_f32 v1, v1, v69, v70
  v_max3_f32 v1, v1, v71, 0
  v_max3_f32 v4, v72, v73, v74
  v_max3_f32 v4, v4, v75, v76
  v_max3_f32 v4, v4, v77, v78
  v_max3_f32 v4, v4, v79, 0
  v_mov_b32 v6, v1
  v_mov_b32 v7, v4
  s_nop 0
  v_permlane16_swap_b32 v6, v1
  v_permlane16_swap_b32 v7, v4
  v_max_f32 v1, v1, v6
  v_max_f32 v4, v4, v7
  v_mov_b32 v6, v1
  v_mov_b32 v7, v4
  s_nop 0
  v_permlane32_swap_b32 v6, v1
  v_permlane32_swap_b32 v7, v4
  v_max_f32 v1, v1, v6
  v_max_f32 v4, v4, v7
  v_exp_f32 v6, -v1
  v_exp_f32 v7, -v4
  v_sub_f32 v24, v24, v1
  v_sub_f32 v25, v25, v1
  v_sub_f32 v26, v26, v1
  v_sub_f32 v27, v27, v1
  v_sub_f32 v64, v64, v1
  v_sub_f32 v65, v65, v1
  v_sub_f32 v66, v66, v1
  v_sub_f32 v67, v67, v1
  v_sub_f32 v68, v68, v1
  v_sub_f32 v69, v69, v1
  v_sub_f32 v70, v70, v1
  v_sub_f32 v71, v71, v1
  v_sub_f32 v48, v48, v1
  v_sub_f32 v49, v49, v1
  v_sub_f32 v50, v50, v1
  v_sub_f32 v51, v51, v1
  v_sub_f32 v52, v52, v1
  v_sub_f32 v53, v53, v1
  v_sub_f32 v54, v54, v1
  v_sub_f32 v55, v55, v1
  v_mul_f32 v22, v6, v22
  v_sub_f32 v28, v28, v4
  v_sub_f32 v29, v29, v4
  v_sub_f32 v30, v30, v4
  v_sub_f32 v31, v31, v4
  v_sub_f32 v72, v72, v4
  v_sub_f32 v73, v73, v4
  v_sub_f32 v74, v74, v4
  v_sub_f32 v75, v75, v4
  v_sub_f32 v76, v76, v4
  v_sub_f32 v77, v77, v4
  v_sub_f32 v78, v78, v4
  v_sub_f32 v79, v79, v4
  v_sub_f32 v56, v56, v4
  v_sub_f32 v57, v57, v4
  v_sub_f32 v58, v58, v4
  v_sub_f32 v59, v59, v4
  v_sub_f32 v60, v60, v4
  v_sub_f32 v61, v61, v4
  v_sub_f32 v62, v62, v4
  v_sub_f32 v63, v63, v4
  v_mul_f32 v23, v7, v23
  v_exp_f32 v80, v64
  v_exp_f32 v81, v65
  v_exp_f32 v82, v66
  v_add_f32 v8, v80, v81
  v_cvt_pk_bf16_f32 v40, v80, v81
  v_exp_f32 v83, v67
  v_add_f32 v8, v8, v82
  v_exp_f32 v84, v68
  v_add_f32 v8, v8, v83
  v_cvt_pk_bf16_f32 v41, v82, v83
  v_exp_f32 v85, v69
  v_add_f32 v8, v8, v84
  v_exp_f32 v86, v70
  v_add_f32 v8, v8, v85
  v_cvt_pk_bf16_f32 v42, v84, v85
  v_exp_f32 v87, v71
  v_add_f32 v8, v8, v86
  v_exp_f32 v88, v72
  v_add_f32 v8, v8, v87
  v_cvt_pk_bf16_f32 v43, v86, v87
  v_exp_f32 v89, v73
  v_exp_f32 v90, v74
  v_add_f32 v9, v88, v89
  v_cvt_pk_bf16_f32 v44, v88, v89
  v_exp_f32 v91, v75
  v_add_f32 v9, v9, v90
  v_exp_f32 v92, v76
  v_add_f32 v9, v9, v91
  v_cvt_pk_bf16_f32 v45, v90, v91
  v_exp_f32 v93, v77
  v_add_f32 v9, v9, v92
  v_exp_f32 v94, v78
  v_add_f32 v9, v9, v93
  v_cvt_pk_bf16_f32 v46, v92, v93
  v_exp_f32 v95, v79
  v_add_f32 v9, v9, v94
  v_add_f32 v9, v9, v95
  v_cvt_pk_bf16_f32 v47, v94, v95
  v_mul_f32 v128, v6, v128
  v_mul_f32 v129, v6, v129
  v_mul_f32 v130, v6, v130
  v_mul_f32 v131, v6, v131
  v_mul_f32 v132, v7, v132
  v_mul_f32 v133, v7, v133
  v_mul_f32 v134, v7, v134
  v_mul_f32 v135, v7, v135
  v_mul_f32 v136, v6, v136
  v_mul_f32 v137, v6, v137
  v_mul_f32 v138, v6, v138
  v_mul_f32 v139, v6, v139
  v_mul_f32 v140, v7, v140
  v_mul_f32 v141, v7, v141
  v_mul_f32 v142, v7, v142
  v_mul_f32 v143, v7, v143
  v_mul_f32 v144, v6, v144
  v_mul_f32 v145, v6, v145
  v_mul_f32 v146, v6, v146
  v_mul_f32 v147, v6, v147
  v_mul_f32 v148, v7, v148
  v_mul_f32 v149, v7, v149
  v_mul_f32 v150, v7, v150
  v_mul_f32 v151, v7, v151
  v_mul_f32 v152, v6, v152
  v_mul_f32 v153, v6, v153
  v_mul_f32 v154, v6, v154
  v_mul_f32 v155, v6, v155
  v_mul_f32 v156, v7, v156
  v_mul_f32 v157, v7, v157
  v_mul_f32 v158, v7, v158
  v_mul_f32 v159, v7, v159
  v_mul_f32 v160, v6, v160
  v_mul_f32 v161, v6, v161
  v_mul_f32 v162, v6, v162
  v_mul_f32 v163, v6, v163
  v_mul_f32 v164, v7, v164
  v_mul_f32 v165, v7, v165
  v_mul_f32 v166, v7, v166
  v_mul_f32 v167, v7, v167
  v_mul_f32 v168, v6, v168
  v_mul_f32 v169, v6, v169
  v_mul_f32 v170, v6, v170
  v_mul_f32 v171, v6, v171
  v_mul_f32 v172, v7, v172
  v_mul_f32 v173, v7, v173
  v_mul_f32 v174, v7, v174
  v_mul_f32 v175, v7, v175
  v_mul_f32 v176, v6, v176
  v_mul_f32 v177, v6, v177
  v_mul_f32 v178, v6, v178
  v_mul_f32 v179, v6, v179
  v_mul_f32 v180, v7, v180
  v_mul_f32 v181, v7, v181
  v_mul_f32 v182, v7, v182
  v_mul_f32 v183, v7, v183
  v_mul_f32 v184, v6, v184
  v_mul_f32 v185, v6, v185
  v_mul_f32 v186, v6, v186
  v_mul_f32 v187, v6, v187
  v_mul_f32 v188, v7, v188
  v_mul_f32 v189, v7, v189
  v_mul_f32 v190, v7, v190
  v_mul_f32 v191, v7, v191
  v_mul_f32 v192, v6, v192
  v_mul_f32 v193, v6, v193
  v_mul_f32 v194, v6, v194
  v_mul_f32 v195, v6, v195
  v_mul_f32 v196, v7, v196
  v_mul_f32 v197, v7, v197
  v_mul_f32 v198, v7, v198
  v_mul_f32 v199, v7, v199
  v_mul_f32 v200, v6, v200
  v_mul_f32 v201, v6, v201
  v_mul_f32 v202, v6, v202
  v_mul_f32 v203, v6, v203
  v_mul_f32 v204, v7, v204
  v_mul_f32 v205, v7, v205
  v_mul_f32 v206, v7, v206
  v_mul_f32 v207, v7, v207
  v_mul_f32 v208, v6, v208
  v_mul_f32 v209, v6, v209
  v_mul_f32 v210, v6, v210
  v_mul_f32 v211, v6, v211
  v_mul_f32 v212, v7, v212
  v_mul_f32 v213, v7, v213
  v_mul_f32 v214, v7, v214
  v_mul_f32 v215, v7, v215
  v_mul_f32 v216, v6, v216
  v_mul_f32 v217, v6, v217
  v_mul_f32 v218, v6, v218
  v_mul_f32 v219, v6, v219
  v_mul_f32 v220, v7, v220
  v_mul_f32 v221, v7, v221
  v_mul_f32 v222, v7, v222
  v_mul_f32 v223, v7, v223
  v_mul_f32 v224, v6, v224
  v_mul_f32 v225, v6, v225
  v_mul_f32 v226, v6, v226
  v_mul_f32 v227, v6, v227
  v_mul_f32 v228, v7, v228
  v_mul_f32 v229, v7, v229
  v_mul_f32 v230, v7, v230
  v_mul_f32 v231, v7, v231
  v_mul_f32 v232, v6, v232
  v_mul_f32 v233, v6, v233
  v_mul_f32 v234, v6, v234
  v_mul_f32 v235, v6, v235
  v_mul_f32 v236, v7, v236
  v_mul_f32 v237, v7, v237
  v_mul_f32 v238, v7, v238
  v_mul_f32 v239, v7, v239
  v_mul_f32 v240, v6, v240
  v_mul_f32 v241, v6, v241
  v_mul_f32 v242, v6, v242
  v_mul_f32 v243, v6, v243
  v_mul_f32 v244, v7, v244
  v_mul_f32 v245, v7, v245
  v_mul_f32 v246, v7, v246
  v_mul_f32 v247, v7, v247
  v_mul_f32 v248, v6, v248
  v_mul_f32 v249, v6, v249
  v_mul_f32 v250, v6, v250
  v_mul_f32 v251, v6, v251
  v_mul_f32 v252, v7, v252
  v_mul_f32 v253, v7, v253
  v_mul_f32 v254, v7, v254
  v_mul_f32 v255, v7, v255
  s_nop 1
  s_branch L_back7
L_rare8:
  v_max3_f32 v1, v48, v49, v50
  v_max3_f32 v1, v1, v51, v52
  v_max3_f32 v1, v1, v53, v54
  v_max3_f32 v1, v1, v55, 0
  v_max3_f32 v4, v56, v57, v58
  v_max3_f32 v4, v4, v59, v60
  v_max3_f32 v4, v4, v61, v62
  v_max3_f32 v4, v4, v63, 0
  v_mov_b32 v6, v1
  v_mov_b32 v7, v4
  s_nop 0
  v_permlane16_swap_b32 v6, v1
  v_permlane16_swap_b32 v7, v4
  v_max_f32 v1, v1, v6
  v_max_f32 v4, v4, v7
  v_mov_b32 v6, v1
  v_mov_b32 v7, v4
  s_nop 0
  v_permlane32_swap_b32 v6, v1
  v_permlane32_swap_b32 v7, v4
  v_max_f32 v1, v1, v6
  v_max_f32 v4, v4, v7
  v_exp_f32 v6, -v1
  v_exp_f32 v7, -v4
  v_sub_f32 v24, v24, v1
  v_sub_f32 v25, v25, v1
  v_sub_f32 v26, v26, v1
  v_sub_f32 v27, v27, v1
  v_sub_f32 v48, v48, v1
  v_sub_f32 v49, v49, v1
  v_sub_f32 v50, v50, v1
  v_sub_f32 v51, v51, v1
  v_sub_f32 v52, v52, v1
  v_sub_f32 v53, v53, v1
  v_sub_f32 v54, v54, v1
  v_sub_f32 v55, v55, v1
  v_sub_f32 v64, v64, v1
  v_sub_f32 v65, v65, v1
  v_sub_f32 v66, v66, v1
  v_sub_f32 v67, v67, v1
  v_sub_f32 v68, v68, v1
  v_sub_f32 v69, v69, v1
  v_sub_f32 v70, v70, v1
  v_sub_f32 v71, v71, v1
  v_mul_f32 v22, v6, v22
  v_sub_f32 v28, v28, v4
  v_sub_f32 v29, v29, v4
  v_sub_f32 v30, v30, v4
  v_sub_f32 v31, v31, v4
  v_sub_f32 v56, v56, v4
  v_sub_f32 v57, v57, v4
  v_sub_f32 v58, v58, v4
  v_sub_f32 v59, v59, v4
  v_sub_f32 v60, v60, v4
  v_sub_f32 v61, v61, v4
  v_sub_f32 v62, v62, v4
  v_sub_f32 v63, v63, v4
  v_sub_f32 v72, v72, v4
  v_sub_f32 v73, v73, v4
  v_sub_f32 v74, v74, v4
  v_sub_f32 v75, v75, v4
  v_sub_f32 v76, v76, v4
  v_sub_f32 v77, v77, v4
  v_sub_f32 v78, v78, v4
  v_sub_f32 v79, v79, v4
  v_mul_f32 v23, v7, v23
  v_exp_f32 v80, v48
  v_exp_f32 v81, v49
  v_exp_f32 v82, v50
  v_add_f32 v8, v80, v81
  v_cvt_pk_bf16_f32 v32, v80, v81
  v_exp_f32 v83, v51
  v_add_f32 v8, v8, v82
  v_exp_f32 v84, v52
  v_add_f32 v8, v8, v83
  v_cvt_pk_bf16_f32 v33, v82, v83
  v_exp_f32 v85, v53
  v_add_f32 v8, v8, v84
  v_exp_f32 v86, v54
  v_add_f32 v8, v8, v85
  v_cvt_pk_bf16_f32 v34, v84, v85
  v_exp_f32 v87, v55
  v_add_f32 v8, v8, v86
  v_exp_f32 v88, v56
  v_add_f32 v8, v8, v87
  v_cvt_pk_bf16_f32 v35, v86, v87
  v_exp_f32 v89, v57
  v_exp_f32 v90, v58
  v_add_f32 v9, v88, v89
  v_cvt_pk_bf16_f32 v36, v88, v89
  v_exp_f32 v91, v59
  v_add_f32 v9, v9, v90
  v_exp_f32 v92, v60
  v_add_f32 v9, v9, v91
  v_cvt_pk_bf16_f32 v37, v90, v91
  v_exp_f32 v93, v61
  v_add_f32 v9, v9, v92
  v_exp_f32 v94, v62
  v_add_f32 v9, v9, v93
  v_cvt_pk_bf16_f32 v38, v92, v93
  v_exp_f32 v95, v63
  v_add_f32 v9, v9, v94
  v_add_f32 v9, v9, v95
  v_cvt_pk_bf16_f32 v39, v94, v95
  v_mul_f32 v128, v6, v128
  v_mul_f32 v129, v6, v129
  v_mul_f32 v130, v6, v130
  v_mul_f32 v131, v6, v131
  v_mul_f32 v132, v7, v132
  v_mul_f32 v133, v7, v133
  v_mul_f32 v134, v7, v134
  v_mul_f32 v135, v7, v135
  v_mul_f32 v136, v6, v136
  v_mul_f32 v137, v6, v137
  v_mul_f32 v138, v6, v138
  v_mul_f32 v139, v6, v139
  v_mul_f32 v140, v7, v140
  v_mul_f32 v141, v7, v141
  v_mul_f32 v142, v7, v142
  v_mul_f32 v143, v7, v143
  v_mul_f32 v144, v6, v144
  v_mul_f32 v145, v6, v145
  v_mul_f32 v146, v6, v146
  v_mul_f32 v147, v6, v147
  v_mul_f32 v148, v7, v148
  v_mul_f32 v149, v7, v149
  v_mul_f32 v150, v7, v150
  v_mul_f32 v151, v7, v151
  v_mul_f32 v152, v6, v152
  v_mul_f32 v153, v6, v153
  v_mul_f32 v154, v6, v154
  v_mul_f32 v155, v6, v155
  v_mul_f32 v156, v7, v156
  v_mul_f32 v157, v7, v157
  v_mul_f32 v158, v7, v158
  v_mul_f32 v159, v7, v159
  v_mul_f32 v160, v6, v160
  v_mul_f32 v161, v6, v161
  v_mul_f32 v162, v6, v162
  v_mul_f32 v163, v6, v163
  v_mul_f32 v164, v7, v164
  v_mul_f32 v165, v7, v165
  v_mul_f32 v166, v7, v166
  v_mul_f32 v167, v7, v167
  v_mul_f32 v168, v6, v168
  v_mul_f32 v169, v6, v169
  v_mul_f32 v170, v6, v170
  v_mul_f32 v171, v6, v171
  v_mul_f32 v172, v7, v172
  v_mul_f32 v173, v7, v173
  v_mul_f32 v174, v7, v174
  v_mul_f32 v175, v7, v175
  v_mul_f32 v176, v6, v176
  v_mul_f32 v177, v6, v177
  v_mul_f32 v178, v6, v178
  v_mul_f32 v179, v6, v179
  v_mul_f32 v180, v7, v180
  v_mul_f32 v181, v7, v181
  v_mul_f32 v182, v7, v182
  v_mul_f32 v183, v7, v183
  v_mul_f32 v184, v6, v184
  v_mul_f32 v185, v6, v185
  v_mul_f32 v186, v6, v186
  v_mul_f32 v187, v6, v187
  v_mul_f32 v188, v7, v188
  v_mul_f32 v189, v7, v189
  v_mul_f32 v190, v7, v190
  v_mul_f32 v191, v7, v191
  v_mul_f32 v192, v6, v192
  v_mul_f32 v193, v6, v193
  v_mul_f32 v194, v6, v194
  v_mul_f32 v195, v6, v195
  v_mul_f32 v196, v7, v196
  v_mul_f32 v197, v7, v197
  v_mul_f32 v198, v7, v198
  v_mul_f32 v199, v7, v199
  v_mul_f32 v200, v6, v200
  v_mul_f32 v201, v6, v201
  v_mul_f32 v202, v6, v202
  v_mul_f32 v203, v6, v203
  v_mul_f32 v204, v7, v204
  v_mul_f32 v205, v7, v205
  v_mul_f32 v206, v7, v206
  v_mul_f32 v207, v7, v207
  v_mul_f32 v208, v6, v208
  v_mul_f32 v209, v6, v209
  v_mul_f32 v210, v6, v210
  v_mul_f32 v211, v6, v211
  v_mul_f32 v212, v7, v212
  v_mul_f32 v213, v7, v213
  v_mul_f32 v214, v7, v214
  v_mul_f32 v215, v7, v215
  v_mul_f32 v216, v6, v216
  v_mul_f32 v217, v6, v217
  v_mul_f32 v218, v6, v218
  v_mul_f32 v219, v6, v219
  v_mul_f32 v220, v7, v220
  v_mul_f32 v221, v7, v221
  v_mul_f32 v222, v7, v222
  v_mul_f32 v223, v7, v223
  v_mul_f32 v224, v6, v224
  v_mul_f32 v225, v6, v225
  v_mul_f32 v226, v6, v226
  v_mul_f32 v227, v6, v227
  v_mul_f32 v228, v7, v228
  v_mul_f32 v229, v7, v229
  v_mul_f32 v230, v7, v230
  v_mul_f32 v231, v7, v231
  v_mul_f32 v232, v6, v232
  v_mul_f32 v233, v6, v233
  v_mul_f32 v234, v6, v234
  v_mul_f32 v235, v6, v235
  v_mul_f32 v236, v7, v236
  v_mul_f32 v237, v7, v237
  v_mul_f32 v238, v7, v238
  v_mul_f32 v239, v7, v239
  v_mul_f32 v240, v6, v240
  v_mul_f32 v241, v6, v241
  v_mul_f32 v242, v6, v242
  v_mul_f32 v243, v6, v243
  v_mul_f32 v244, v7, v244
  v_mul_f32 v245, v7, v245
  v_mul_f32 v246, v7, v246
  v_mul_f32 v247, v7, v247
  v_mul_f32 v248, v6, v248
  v_mul_f32 v249, v6, v249
  v_mul_f32 v250, v6, v250
  v_mul_f32 v251, v6, v251
  v_mul_f32 v252, v7, v252
  v_mul_f32 v253, v7, v253
  v_mul_f32 v254, v7, v254
  v_mul_f32 v255, v7, v255
  s_nop 1
  s_branch L_back8
L_codeend:
.section .rodata,"a"
.p2align 6
.amdhsa_kernel standalone__gqa_softmax__near_ridge_kernel
  .amdhsa_next_free_vgpr 452
  .amdhsa_next_free_sgpr 102
  .amdhsa_accum_offset 256
  .amdhsa_group_segment_fixed_size 0
  .amdhsa_kernarg_size 48
  .amdhsa_user_sgpr_count 2
  .amdhsa_user_sgpr_kernarg_segment_ptr 1
  .amdhsa_system_sgpr_workgroup_id_x 1
.end_amdhsa_kernel
```
